```python
import torch

def _softmax(x, axis=-1):
    return torch.softmax(x, dim=axis)
def _gelu(x):
    return torch.nn.functional.gelu(x, approximate="tanh")
def _silu(x):
    return torch.nn.functional.silu(x)
def _sigmoid(x):
    return torch.sigmoid(x)
def _layernorm(x, axis=-1, eps=1e-5):
    m = x.mean(dim=axis, keepdim=True)
    v = x.var(dim=axis, keepdim=True, unbiased=False)
    return (x - m) / torch.sqrt(v + eps)
def _scatter_add(tgt, idx, src, axis=0):
    return tgt.clone().index_add_(axis, idx, src)
def _segment_sum(src, seg, n):
    out = torch.zeros((n,) + src.shape[1:], dtype=src.dtype)
    return out.index_add_(0, seg, src)
def _pad(x, pw):
    flat = tuple(v for pair in reversed(pw) for v in pair)
    return torch.nn.functional.pad(x, flat)

kernel_name = 'concat_heads__mha_block_cached__mha_block_cached__near_ridge'

def setup_inputs():

    _w = (lambda a: (lambda t: t.to(torch.bfloat16) if t.is_floating_point() else t)(torch.as_tensor(a)))
    def _A_setup():
        B, Sq, D = 32, 64, 512
        H, Sk, Dh = 32, 512, 128
        return {
            "x": _w((lambda *s: torch.randn(*s, dtype=torch.bfloat16) * 0.8)(B, Sq, D)),
            "k_cache": _w((lambda *s: torch.randn(*s, dtype=torch.bfloat16) * 0.8)(B, H, Sk, Dh)),
            "v_cache": _w((lambda *s: torch.randn(*s, dtype=torch.bfloat16) * 0.05)(B, H, Sk, Dh)),
            "wq": _w((lambda *s: torch.randn(*s, dtype=torch.bfloat16) * 0.8)(D, H * Dh) * (D ** -0.5)),
            "wo": _w((lambda *s: torch.randn(*s, dtype=torch.bfloat16) * 0.05)(H * Dh, D) * ((H * Dh) ** -0.5)),
        }
    _A_in = _A_setup()

    def _B_setup():
        B, Sq, D = 32, 64, 512
        H, Sk, Dh = 32, 512, 128
        return {
            "x": _w((lambda *s: torch.randn(*s, dtype=torch.bfloat16) * 0.8)(B, Sq, D)),
            "k_cache": _w((lambda *s: torch.randn(*s, dtype=torch.bfloat16) * 0.8)(B, H, Sk, Dh)),
            "v_cache": _w((lambda *s: torch.randn(*s, dtype=torch.bfloat16) * 0.05)(B, H, Sk, Dh)),
            "wq": _w((lambda *s: torch.randn(*s, dtype=torch.bfloat16) * 0.8)(D, H * Dh) * (D ** -0.5)),
            "wo": _w((lambda *s: torch.randn(*s, dtype=torch.bfloat16) * 0.05)(H * Dh, D) * ((H * Dh) ** -0.5)),
        }
    _B_in = _B_setup()

    return {
        "A_x": _A_in["x"],
        "A_k_cache": _A_in["k_cache"],
        "A_v_cache": _A_in["v_cache"],
        "A_wq": _A_in["wq"],
        "A_wo": _A_in["wo"],
        "B_x": _B_in["x"],
        "B_k_cache": _B_in["k_cache"],
        "B_v_cache": _B_in["v_cache"],
        "B_wq": _B_in["wq"],
        "B_wo": _B_in["wo"],
    }

def reference(A_x, A_k_cache, A_v_cache, A_wq, A_wo, B_x, B_k_cache, B_v_cache, B_wq, B_wo):
    def _A_ref(x, k_cache, v_cache, wq, wo):
        B, Sq, D = x.shape
        H, Dh = 32, 128
        q = (lambda x, *d: x.permute(*d))((x @ wq).reshape(B, Sq, H, Dh), 0, 2, 1, 3)
        scores = torch.einsum("bhqd,bhkd->bhqk", q, k_cache) * (Dh ** -0.5)
        p = _softmax(scores, axis=-1)
        o = torch.einsum("bhqk,bhkd->bhqd", p, v_cache)
        return (lambda x, *d: x.permute(*d))(o, 0, 2, 1, 3).reshape(B, Sq, H * Dh) @ wo

    def _B_ref(x, k_cache, v_cache, wq, wo):
        B, Sq, D = x.shape
        H, Dh = 32, 128
        q = (lambda x, *d: x.permute(*d))((x @ wq).reshape(B, Sq, H, Dh), 0, 2, 1, 3)
        scores = torch.einsum("bhqd,bhkd->bhqk", q, k_cache) * (Dh ** -0.5)
        p = _softmax(scores, axis=-1)
        o = torch.einsum("bhqk,bhkd->bhqd", p, v_cache)
        return (lambda x, *d: x.permute(*d))(o, 0, 2, 1, 3).reshape(B, Sq, H * Dh) @ wo

    a = _A_ref(A_x, A_k_cache, A_v_cache, A_wq, A_wo)
    b = _B_ref(B_x, B_k_cache, B_v_cache, B_wq, B_wo)
    return torch.concatenate([a, b], axis=-1)
```

```asm
; @launch kernel=concat_heads__mha_block_cached__mha_block_cached__near_ridge_kernel grid=(256,1,1) block=(256,1,1) lds=163840
; @launch kernel=mha_reduce_kernel grid=(512,1,1) block=(256,1,1) lds=0
.amdgcn_target "amdgcn-amd-amdhsa--gfx950"
.text
.globl concat_heads__mha_block_cached__mha_block_cached__near_ridge_kernel
.p2align 8
.type concat_heads__mha_block_cached__mha_block_cached__near_ridge_kernel,@function
concat_heads__mha_block_cached__mha_block_cached__near_ridge_kernel:
s_cmp_ge_u32 s2, 256
s_cbranch_scc1 L_end
s_load_dwordx8 s[36:43], s[0:1], 0
s_load_dwordx2 s[44:45], s[0:1], 32
s_load_dwordx8 s[48:55], s[0:1], 40
s_load_dwordx2 s[56:57], s[0:1], 72
s_load_dwordx2 s[58:59], s[0:1], 96
s_lshr_b32 s69, s2, 2
s_and_b32 s69, s69, 1
s_and_b32 s68, s2, 3
s_lshr_b32 s67, s2, 3
v_lshrrev_b32 v1, 6, v0
v_and_b32 v2, 63, v0
v_readfirstlane_b32 s65, v1
v_lshrrev_b32 v10, 4, v2
v_and_b32 v11, 15, v2
v_lshlrev_b32 v12, 2, v10
v_xor_b32 v12, v12, v11
v_lshlrev_b32 v12, 4, v12
v_lshl_add_u32 v237, v10, 8, v12
v_lshl_add_u32 v239, v10, 13, v12
v_xor_b32 v13, v10, v11
v_lshlrev_b32 v13, 4, v13
v_lshl_add_u32 v236, v10, 8, v13
v_lshlrev_b32 v238, 4, v2
s_waitcnt lgkmcnt(0)
s_cmp_eq_u32 s69, 0
s_cselect_b32 s36, s36, s48
s_cselect_b32 s37, s37, s49
s_cselect_b32 s38, s38, s50
s_cselect_b32 s39, s39, s51
s_cselect_b32 s40, s40, s52
s_cselect_b32 s41, s41, s53
s_cselect_b32 s42, s42, s54
s_cselect_b32 s43, s43, s55
s_cselect_b32 s44, s44, s56
s_cselect_b32 s45, s45, s57
s_lshl_b32 s63, s67, 22
s_lshl_b32 s64, s68, 20
s_add_u32 s63, s63, s64
s_add_u32 s8, s38, s63
s_addc_u32 s9, s39, 0
s_mov_b32 s10, 0x100000
s_mov_b32 s11, 0x20000
s_add_u32 s12, s40, s63
s_addc_u32 s13, s41, 0
s_mov_b32 s14, 0x100000
s_mov_b32 s15, 0x20000
s_lshl_b32 s63, s68, 11
s_add_u32 s16, s42, s63
s_addc_u32 s17, s43, 0
s_sub_u32 s18, 0x400000, s63
s_mov_b32 s19, 0x20000
s_add_u32 s20, s44, s64
s_addc_u32 s21, s45, 0
s_mov_b32 s22, 0x100000
s_mov_b32 s23, 0x20000
s_sub_u32 s46, s20, 0x20000
s_subb_u32 s47, s21, 0
s_lshl_b32 s63, s67, 16
s_add_u32 s24, s36, s63
s_addc_u32 s25, s37, 0
s_mov_b32 s26, 0x10000
s_mov_b32 s27, 0x20000
s_lshr_b32 s28, s65, 1
s_and_b32 s66, s65, 1
s_lshl_b32 s71, s65, 12
s_mov_b32 s62, 0x3e0293ee
s_mov_b32 s33, 0
s_mov_b32 s34, 81920
s_mov_b32 s30, s71
s_sub_u32 s31, s71, 131072
s_lshl_b32 s32, s65, 17
s_mov_b32 s60, 65536
s_mov_b32 s61, 114688
s_mov_b32 s29, 0
s_lshl_b32 s74, s67, 17
s_lshl_b32 s63, s65, 15
s_add_u32 s74, s74, s63
s_sub_u32 s74, s74, s32
s_lshl_b32 s75, s67, 12
s_lshl_b32 s63, s65, 10
s_add_u32 s75, s75, s63
s_sub_u32 s75, s75, s71
v_lshrrev_b32 v13, 3, v2
v_and_b32 v14, 7, v2
v_lshrrev_b32 v15, 1, v13
v_xor_b32 v14, v14, v15
v_lshlrev_b32 v14, 4, v14
v_lshl_add_u32 v14, v13, 10, v14
v_xor_b32 v15, 64, v14
s_lshl_b32 s4, s65, 14
s_lshl_b32 s5, s65, 11
s_mov_b32 s6, 0x80000000
s_add_u32 s63, s32, s74
buffer_load_dword v243, v239, s[16:19], s63 offen
s_add_u32 s63, s4, 0
s_add_u32 m0, s5, 16384
s_nop 0
buffer_load_dwordx4 v14, s[24:27], s63 offen lds
s_add_u32 s63, s4, 8192
s_add_u32 m0, s5, 17408
s_nop 0
buffer_load_dwordx4 v15, s[24:27], s63 offen lds
s_add_u32 m0, s71, 81920
s_add_u32 s3, s32, 0
buffer_load_dwordx4 v239, s[16:19], s3 offen offset:0 lds
s_add_u32 s3, s32, 31744
buffer_load_dwordx4 v239, s[16:19], s3 offen offset:1024 lds
s_add_u32 s3, s32, 63488
buffer_load_dwordx4 v239, s[16:19], s3 offen offset:2048 lds
s_add_u32 s3, s32, 95232
buffer_load_dwordx4 v239, s[16:19], s3 offen offset:3072 lds
s_add_u32 s63, s4, 128
s_add_u32 m0, s5, 24576
s_nop 0
buffer_load_dwordx4 v14, s[24:27], s63 offen lds
s_add_u32 s63, s4, 8320
s_add_u32 m0, s5, 25600
s_nop 0
buffer_load_dwordx4 v15, s[24:27], s63 offen lds
s_add_u32 m0, s71, 98304
s_add_u32 s3, s32, 524288
buffer_load_dwordx4 v239, s[16:19], s3 offen offset:0 lds
s_add_u32 s3, s32, 556032
buffer_load_dwordx4 v239, s[16:19], s3 offen offset:1024 lds
s_add_u32 s3, s32, 587776
buffer_load_dwordx4 v239, s[16:19], s3 offen offset:2048 lds
s_add_u32 s3, s32, 619520
buffer_load_dwordx4 v239, s[16:19], s3 offen offset:3072 lds
s_add_u32 s63, s32, s74
s_add_u32 s63, s63, 256
buffer_load_dword v243, v239, s[16:19], s63 offen
s_add_u32 s63, s4, 256
s_add_u32 m0, s5, 32768
s_nop 0
buffer_load_dwordx4 v14, s[24:27], s63 offen lds
s_add_u32 s63, s4, 8448
s_add_u32 m0, s5, 33792
s_nop 0
buffer_load_dwordx4 v15, s[24:27], s63 offen lds
s_add_u32 m0, s71, 114688
s_add_u32 s3, s32, 1048576
buffer_load_dwordx4 v239, s[16:19], s3 offen offset:0 lds
s_add_u32 s3, s32, 1080320
buffer_load_dwordx4 v239, s[16:19], s3 offen offset:1024 lds
s_add_u32 s3, s32, 1112064
buffer_load_dwordx4 v239, s[16:19], s3 offen offset:2048 lds
s_add_u32 s3, s32, 1143808
buffer_load_dwordx4 v239, s[16:19], s3 offen offset:3072 lds
s_add_u32 s63, s4, 384
s_add_u32 m0, s5, 40960
s_nop 0
buffer_load_dwordx4 v14, s[24:27], s63 offen lds
s_add_u32 s63, s4, 8576
s_add_u32 m0, s5, 41984
s_nop 0
buffer_load_dwordx4 v15, s[24:27], s63 offen lds
s_add_u32 m0, s71, 131072
s_add_u32 s3, s32, 1572864
buffer_load_dwordx4 v239, s[16:19], s3 offen offset:0 lds
s_add_u32 s3, s32, 1604608
buffer_load_dwordx4 v239, s[16:19], s3 offen offset:1024 lds
s_add_u32 s3, s32, 1636352
buffer_load_dwordx4 v239, s[16:19], s3 offen offset:2048 lds
s_add_u32 s3, s32, 1668096
buffer_load_dwordx4 v239, s[16:19], s3 offen offset:3072 lds
s_add_u32 s63, s4, 512
s_add_u32 m0, s5, 49152
s_nop 0
buffer_load_dwordx4 v14, s[24:27], s63 offen lds
s_add_u32 s63, s4, 8704
s_add_u32 m0, s5, 50176
s_nop 0
buffer_load_dwordx4 v15, s[24:27], s63 offen lds
s_add_u32 m0, s71, 147456
s_add_u32 s3, s32, 2097152
buffer_load_dwordx4 v239, s[16:19], s3 offen offset:0 lds
s_add_u32 s3, s32, 2128896
buffer_load_dwordx4 v239, s[16:19], s3 offen offset:1024 lds
s_add_u32 s3, s32, 2160640
buffer_load_dwordx4 v239, s[16:19], s3 offen offset:2048 lds
s_add_u32 s3, s32, 2192384
buffer_load_dwordx4 v239, s[16:19], s3 offen offset:3072 lds
s_add_u32 s63, s4, 640
s_add_u32 m0, s5, 57344
s_nop 0
buffer_load_dwordx4 v14, s[24:27], s63 offen lds
s_add_u32 s63, s4, 8832
s_add_u32 m0, s5, 58368
s_nop 0
buffer_load_dwordx4 v15, s[24:27], s63 offen lds
s_add_u32 s63, s4, 768
s_add_u32 m0, s5, 65536
s_nop 0
buffer_load_dwordx4 v14, s[24:27], s63 offen lds
s_add_u32 s63, s4, 8960
s_add_u32 m0, s5, 66560
s_nop 0
buffer_load_dwordx4 v15, s[24:27], s63 offen lds
s_add_u32 s63, s4, 896
s_add_u32 m0, s5, 73728
s_nop 0
buffer_load_dwordx4 v14, s[24:27], s63 offen lds
s_add_u32 s63, s4, 9088
s_add_u32 m0, s5, 74752
s_nop 0
buffer_load_dwordx4 v15, s[24:27], s63 offen lds
s_add_u32 m0, s33, s71
s_add_u32 s7, s30, 0
buffer_load_dwordx4 v236, s[8:11], s7 offen offset:0 nt lds
v_xor_b32 v240, 64, v236
buffer_load_dwordx4 v240, s[8:11], s7 offen offset:1024 nt lds
v_xor_b32 v240, 128, v236
buffer_load_dwordx4 v240, s[8:11], s7 offen offset:2048 nt lds
v_xor_b32 v240, 192, v236
buffer_load_dwordx4 v240, s[8:11], s7 offen offset:3072 nt lds
s_add_u32 s33, s33, 16384
s_cmp_ge_u32 s33, 81920
s_cselect_b32 s33, 0, s33
s_add_u32 s63, s31, s75
s_add_u32 s63, s63, 131072
buffer_load_dword v243, v238, s[20:23], s63 offen
s_add_u32 s63, s32, s74
s_add_u32 s63, s63, 512
buffer_load_dword v243, v239, s[16:19], s63 offen
s_add_u32 s63, s31, s75
s_add_u32 s63, s63, 262144
buffer_load_dword v243, v238, s[20:23], s63 offen
s_add_u32 s63, s32, s74
s_add_u32 s63, s63, 768
buffer_load_dword v243, v239, s[16:19], s63 offen
s_add_u32 s63, s31, s75
s_add_u32 s63, s63, 393216
buffer_load_dword v243, v238, s[20:23], s63 offen
s_add_u32 s63, s32, s74
s_add_u32 s63, s63, 1024
buffer_load_dword v243, v239, s[16:19], s63 offen
s_add_u32 s63, s31, s75
s_add_u32 s63, s63, 524288
buffer_load_dword v243, v238, s[20:23], s63 offen
s_add_u32 s63, s32, s74
s_add_u32 s63, s63, 1280
buffer_load_dword v243, v239, s[16:19], s63 offen
s_add_u32 s63, s31, s75
s_add_u32 s63, s63, 655360
buffer_load_dword v243, v238, s[20:23], s63 offen
s_add_u32 s63, s32, s74
s_add_u32 s63, s63, 1536
buffer_load_dword v243, v239, s[16:19], s63 offen
s_add_u32 s63, s31, s75
s_add_u32 s63, s63, 786432
buffer_load_dword v243, v238, s[20:23], s63 offen
s_add_u32 s63, s32, s74
s_add_u32 s63, s63, 1792
buffer_load_dword v243, v239, s[16:19], s63 offen
s_add_u32 s63, s31, s75
s_add_u32 s63, s63, 917504
buffer_load_dword v243, v238, s[20:23], s63 offen
s_add_u32 s63, s31, s75
s_add_u32 s63, s63, 1048576
buffer_load_dword v243, v238, s[20:23], s63 offen
v_lshrrev_b32 v3, 5, v2
v_and_b32 v4, 31, v2
v_bfe_u32 v5, v2, 4, 1
v_bfe_u32 v6, v2, 2, 2
v_and_b32 v7, 3, v2
v_and_b32 v8, 1, v7
v_lshlrev_b32 v8, 1, v8
v_lshrrev_b32 v9, 1, v7
v_or_b32 v8, v8, v9
v_lshlrev_b32 v8, 3, v8
v_lshl_add_u32 v8, v5, 5, v8
v_mov_b32 v9, s28
v_lshlrev_b32 v10, 5, v9
v_lshl_add_u32 v10, v3, 2, v10
v_add_u32 v10, v10, v6
v_lshlrev_b32 v11, 1, v9
v_xor_b32 v11, v11, v6
v_lshlrev_b32 v10, 8, v10
v_lshl_add_u32 v10, v11, 6, v10
v_add_u32 v233, v10, v8
v_lshl_add_u32 v12, v3, 3, v6
v_lshlrev_b32 v10, 8, v12
v_lshl_add_u32 v10, v11, 6, v10
v_add_u32 v234, v10, v8
v_lshlrev_b32 v10, 10, v12
v_lshl_add_u32 v10, v9, 9, v10
v_lshl_add_u32 v10, v6, 6, v10
v_add_u32 v235, v10, v8
v_lshl_add_u32 v10, v9, 5, v4
v_and_b32 v11, 15, v4
v_xor_b32 v11, v11, v3
v_lshlrev_b32 v10, 8, v10
v_lshl_add_u32 v232, v11, 4, v10
s_lshl_b32 s63, s65, 13
s_add_u32 s63, s63, 131072
v_add_u32 v241, s63, v238
s_lshl_b32 s64, s66, 13
s_add_u32 s64, s64, 131072
v_add_u32 v242, s64, v238
s_lshl_b32 s63, s66, 12
s_add_u32 s63, s63, 16384
v_bfe_u32 v11, v4, 1, 3
v_xor_b32 v11, v11, v3
v_lshlrev_b32 v11, 4, v11
v_lshl_add_u32 v11, v4, 7, v11
v_add_u32 v16, s63, v11
v_xor_b32 v17, 32, v16
v_xor_b32 v18, 64, v16
v_xor_b32 v19, 96, v16
v_accvgpr_write_b32 a0, 0
v_accvgpr_write_b32 a1, 0
v_accvgpr_write_b32 a2, 0
v_accvgpr_write_b32 a3, 0
v_accvgpr_write_b32 a4, 0
v_accvgpr_write_b32 a5, 0
v_accvgpr_write_b32 a6, 0
v_accvgpr_write_b32 a7, 0
v_accvgpr_write_b32 a8, 0
v_accvgpr_write_b32 a9, 0
v_accvgpr_write_b32 a10, 0
v_accvgpr_write_b32 a11, 0
v_accvgpr_write_b32 a12, 0
v_accvgpr_write_b32 a13, 0
v_accvgpr_write_b32 a14, 0
v_accvgpr_write_b32 a15, 0
v_accvgpr_write_b32 a16, 0
v_accvgpr_write_b32 a17, 0
v_accvgpr_write_b32 a18, 0
v_accvgpr_write_b32 a19, 0
v_accvgpr_write_b32 a20, 0
v_accvgpr_write_b32 a21, 0
v_accvgpr_write_b32 a22, 0
v_accvgpr_write_b32 a23, 0
v_accvgpr_write_b32 a24, 0
v_accvgpr_write_b32 a25, 0
v_accvgpr_write_b32 a26, 0
v_accvgpr_write_b32 a27, 0
v_accvgpr_write_b32 a28, 0
v_accvgpr_write_b32 a29, 0
v_accvgpr_write_b32 a30, 0
v_accvgpr_write_b32 a31, 0
v_accvgpr_write_b32 a32, 0
v_accvgpr_write_b32 a33, 0
v_accvgpr_write_b32 a34, 0
v_accvgpr_write_b32 a35, 0
v_accvgpr_write_b32 a36, 0
v_accvgpr_write_b32 a37, 0
v_accvgpr_write_b32 a38, 0
v_accvgpr_write_b32 a39, 0
v_accvgpr_write_b32 a40, 0
v_accvgpr_write_b32 a41, 0
v_accvgpr_write_b32 a42, 0
v_accvgpr_write_b32 a43, 0
v_accvgpr_write_b32 a44, 0
v_accvgpr_write_b32 a45, 0
v_accvgpr_write_b32 a46, 0
v_accvgpr_write_b32 a47, 0
v_accvgpr_write_b32 a48, 0
v_accvgpr_write_b32 a49, 0
v_accvgpr_write_b32 a50, 0
v_accvgpr_write_b32 a51, 0
v_accvgpr_write_b32 a52, 0
v_accvgpr_write_b32 a53, 0
v_accvgpr_write_b32 a54, 0
v_accvgpr_write_b32 a55, 0
v_accvgpr_write_b32 a56, 0
v_accvgpr_write_b32 a57, 0
v_accvgpr_write_b32 a58, 0
v_accvgpr_write_b32 a59, 0
v_accvgpr_write_b32 a60, 0
v_accvgpr_write_b32 a61, 0
v_accvgpr_write_b32 a62, 0
v_accvgpr_write_b32 a63, 0
v_accvgpr_write_b32 a64, 0
v_accvgpr_write_b32 a65, 0
v_accvgpr_write_b32 a66, 0
v_accvgpr_write_b32 a67, 0
v_accvgpr_write_b32 a68, 0
v_accvgpr_write_b32 a69, 0
v_accvgpr_write_b32 a70, 0
v_accvgpr_write_b32 a71, 0
v_accvgpr_write_b32 a72, 0
v_accvgpr_write_b32 a73, 0
v_accvgpr_write_b32 a74, 0
v_accvgpr_write_b32 a75, 0
v_accvgpr_write_b32 a76, 0
v_accvgpr_write_b32 a77, 0
v_accvgpr_write_b32 a78, 0
v_accvgpr_write_b32 a79, 0
v_accvgpr_write_b32 a80, 0
v_accvgpr_write_b32 a81, 0
v_accvgpr_write_b32 a82, 0
v_accvgpr_write_b32 a83, 0
v_accvgpr_write_b32 a84, 0
v_accvgpr_write_b32 a85, 0
v_accvgpr_write_b32 a86, 0
v_accvgpr_write_b32 a87, 0
v_accvgpr_write_b32 a88, 0
v_accvgpr_write_b32 a89, 0
v_accvgpr_write_b32 a90, 0
v_accvgpr_write_b32 a91, 0
v_accvgpr_write_b32 a92, 0
v_accvgpr_write_b32 a93, 0
v_accvgpr_write_b32 a94, 0
v_accvgpr_write_b32 a95, 0
v_accvgpr_write_b32 a96, 0
v_accvgpr_write_b32 a97, 0
v_accvgpr_write_b32 a98, 0
v_accvgpr_write_b32 a99, 0
v_accvgpr_write_b32 a100, 0
v_accvgpr_write_b32 a101, 0
v_accvgpr_write_b32 a102, 0
v_accvgpr_write_b32 a103, 0
v_accvgpr_write_b32 a104, 0
v_accvgpr_write_b32 a105, 0
v_accvgpr_write_b32 a106, 0
v_accvgpr_write_b32 a107, 0
v_accvgpr_write_b32 a108, 0
v_accvgpr_write_b32 a109, 0
v_accvgpr_write_b32 a110, 0
v_accvgpr_write_b32 a111, 0
v_accvgpr_write_b32 a112, 0
v_accvgpr_write_b32 a113, 0
v_accvgpr_write_b32 a114, 0
v_accvgpr_write_b32 a115, 0
v_accvgpr_write_b32 a116, 0
v_accvgpr_write_b32 a117, 0
v_accvgpr_write_b32 a118, 0
v_accvgpr_write_b32 a119, 0
v_accvgpr_write_b32 a120, 0
v_accvgpr_write_b32 a121, 0
v_accvgpr_write_b32 a122, 0
v_accvgpr_write_b32 a123, 0
v_accvgpr_write_b32 a124, 0
v_accvgpr_write_b32 a125, 0
v_accvgpr_write_b32 a126, 0
v_accvgpr_write_b32 a127, 0
v_mov_b32 v32, 0
v_mov_b32 v33, 0
v_mov_b32 v34, 0
v_mov_b32 v35, 0
v_mov_b32 v36, 0
v_mov_b32 v37, 0
v_mov_b32 v38, 0
v_mov_b32 v39, 0
v_mov_b32 v40, 0
v_mov_b32 v41, 0
v_mov_b32 v42, 0
v_mov_b32 v43, 0
v_mov_b32 v44, 0
v_mov_b32 v45, 0
v_mov_b32 v46, 0
v_mov_b32 v47, 0
v_mov_b32 v48, 0
v_mov_b32 v49, 0
v_mov_b32 v50, 0
v_mov_b32 v51, 0
v_mov_b32 v52, 0
v_mov_b32 v53, 0
v_mov_b32 v54, 0
v_mov_b32 v55, 0
v_mov_b32 v56, 0
v_mov_b32 v57, 0
v_mov_b32 v58, 0
v_mov_b32 v59, 0
v_mov_b32 v60, 0
v_mov_b32 v61, 0
v_mov_b32 v62, 0
v_mov_b32 v63, 0
v_mov_b32 v252, 0
v_mov_b32 v253, 1.0
v_mov_b32 v254, 0
v_mov_b32 v255, 1.0
v_add_u32 v228, 81920, v234
v_xor_b32 v229, 64, v228
s_waitcnt vmcnt(49)
s_barrier
ds_read_b128 a[128:131], v16 offset:0
ds_read_b128 a[132:135], v17 offset:0
ds_read_b128 a[136:139], v18 offset:0
ds_read_b128 a[140:143], v19 offset:0
ds_read_b64_tr_b16 v[192:193], v228 offset:0
ds_read_b64_tr_b16 v[194:195], v228 offset:1024
ds_read_b64_tr_b16 v[196:197], v229 offset:0
ds_read_b64_tr_b16 v[198:199], v229 offset:1024
ds_read_b64_tr_b16 v[200:201], v228 offset:4096
ds_read_b64_tr_b16 v[202:203], v228 offset:5120
ds_read_b64_tr_b16 v[204:205], v229 offset:4096
ds_read_b64_tr_b16 v[206:207], v229 offset:5120
ds_read_b64_tr_b16 v[208:209], v228 offset:8192
ds_read_b64_tr_b16 v[210:211], v228 offset:9216
ds_read_b64_tr_b16 v[212:213], v229 offset:8192
ds_read_b64_tr_b16 v[214:215], v229 offset:9216
ds_read_b64_tr_b16 v[216:217], v228 offset:12288
ds_read_b64_tr_b16 v[218:219], v228 offset:13312
ds_read_b64_tr_b16 v[220:221], v229 offset:12288
ds_read_b64_tr_b16 v[222:223], v229 offset:13312
s_waitcnt lgkmcnt(14)
v_mfma_f32_32x32x16_bf16 v[160:175], v[192:195], a[128:131], 0
s_waitcnt lgkmcnt(12)
v_mfma_f32_32x32x16_bf16 v[176:191], v[196:199], a[128:131], 0
s_waitcnt lgkmcnt(10)
v_mfma_f32_32x32x16_bf16 v[160:175], v[200:203], a[132:135], v[160:175]
s_waitcnt lgkmcnt(8)
v_mfma_f32_32x32x16_bf16 v[176:191], v[204:207], a[132:135], v[176:191]
s_waitcnt lgkmcnt(6)
v_mfma_f32_32x32x16_bf16 v[160:175], v[208:211], a[136:139], v[160:175]
s_waitcnt lgkmcnt(4)
v_mfma_f32_32x32x16_bf16 v[176:191], v[212:215], a[136:139], v[176:191]
s_waitcnt lgkmcnt(2)
v_mfma_f32_32x32x16_bf16 v[160:175], v[216:219], a[140:143], v[160:175]
s_waitcnt lgkmcnt(0)
v_mfma_f32_32x32x16_bf16 v[176:191], v[220:223], a[140:143], v[176:191]
v_add_u32 v228, 98304, v234
v_xor_b32 v229, 64, v228
s_waitcnt vmcnt(43)
s_barrier
ds_read_b128 a[144:147], v16 offset:8192
ds_read_b128 a[148:151], v17 offset:8192
ds_read_b128 a[152:155], v18 offset:8192
ds_read_b128 a[156:159], v19 offset:8192
ds_read_b64_tr_b16 v[192:193], v228 offset:0
ds_read_b64_tr_b16 v[194:195], v228 offset:1024
ds_read_b64_tr_b16 v[196:197], v229 offset:0
ds_read_b64_tr_b16 v[198:199], v229 offset:1024
ds_read_b64_tr_b16 v[200:201], v228 offset:4096
ds_read_b64_tr_b16 v[202:203], v228 offset:5120
ds_read_b64_tr_b16 v[204:205], v229 offset:4096
ds_read_b64_tr_b16 v[206:207], v229 offset:5120
ds_read_b64_tr_b16 v[208:209], v228 offset:8192
ds_read_b64_tr_b16 v[210:211], v228 offset:9216
ds_read_b64_tr_b16 v[212:213], v229 offset:8192
ds_read_b64_tr_b16 v[214:215], v229 offset:9216
ds_read_b64_tr_b16 v[216:217], v228 offset:12288
ds_read_b64_tr_b16 v[218:219], v228 offset:13312
ds_read_b64_tr_b16 v[220:221], v229 offset:12288
ds_read_b64_tr_b16 v[222:223], v229 offset:13312
s_waitcnt lgkmcnt(14)
v_mfma_f32_32x32x16_bf16 v[160:175], v[192:195], a[144:147], v[160:175]
s_add_u32 m0, s71, 81920
s_add_u32 s3, s32, 2621440
buffer_load_dwordx4 v239, s[16:19], s3 offen offset:0 lds
s_waitcnt lgkmcnt(12)
v_mfma_f32_32x32x16_bf16 v[176:191], v[196:199], a[144:147], v[176:191]
s_waitcnt lgkmcnt(10)
v_mfma_f32_32x32x16_bf16 v[160:175], v[200:203], a[148:151], v[160:175]
s_add_u32 s3, s32, 2653184
buffer_load_dwordx4 v239, s[16:19], s3 offen offset:1024 lds
s_waitcnt lgkmcnt(8)
v_mfma_f32_32x32x16_bf16 v[176:191], v[204:207], a[148:151], v[176:191]
s_waitcnt lgkmcnt(6)
v_mfma_f32_32x32x16_bf16 v[160:175], v[208:211], a[152:155], v[160:175]
s_add_u32 s3, s32, 2684928
buffer_load_dwordx4 v239, s[16:19], s3 offen offset:2048 lds
s_waitcnt lgkmcnt(4)
v_mfma_f32_32x32x16_bf16 v[176:191], v[212:215], a[152:155], v[176:191]
s_waitcnt lgkmcnt(2)
v_mfma_f32_32x32x16_bf16 v[160:175], v[216:219], a[156:159], v[160:175]
s_add_u32 s3, s32, 2716672
buffer_load_dwordx4 v239, s[16:19], s3 offen offset:3072 lds
s_waitcnt lgkmcnt(0)
v_mfma_f32_32x32x16_bf16 v[176:191], v[220:223], a[156:159], v[176:191]
v_add_u32 v228, 114688, v234
v_xor_b32 v229, 64, v228
s_waitcnt vmcnt(40)
s_barrier
ds_read_b128 a[160:163], v16 offset:16384
ds_read_b128 a[164:167], v17 offset:16384
ds_read_b128 a[168:171], v18 offset:16384
ds_read_b128 a[172:175], v19 offset:16384
ds_read_b64_tr_b16 v[192:193], v228 offset:0
ds_read_b64_tr_b16 v[194:195], v228 offset:1024
ds_read_b64_tr_b16 v[196:197], v229 offset:0
ds_read_b64_tr_b16 v[198:199], v229 offset:1024
ds_read_b64_tr_b16 v[200:201], v228 offset:4096
ds_read_b64_tr_b16 v[202:203], v228 offset:5120
ds_read_b64_tr_b16 v[204:205], v229 offset:4096
ds_read_b64_tr_b16 v[206:207], v229 offset:5120
ds_read_b64_tr_b16 v[208:209], v228 offset:8192
ds_read_b64_tr_b16 v[210:211], v228 offset:9216
ds_read_b64_tr_b16 v[212:213], v229 offset:8192
ds_read_b64_tr_b16 v[214:215], v229 offset:9216
ds_read_b64_tr_b16 v[216:217], v228 offset:12288
ds_read_b64_tr_b16 v[218:219], v228 offset:13312
ds_read_b64_tr_b16 v[220:221], v229 offset:12288
ds_read_b64_tr_b16 v[222:223], v229 offset:13312
s_waitcnt lgkmcnt(14)
v_mfma_f32_32x32x16_bf16 v[160:175], v[192:195], a[160:163], v[160:175]
s_add_u32 m0, s71, 98304
s_add_u32 s3, s32, 3145728
buffer_load_dwordx4 v239, s[16:19], s3 offen offset:0 lds
s_waitcnt lgkmcnt(12)
v_mfma_f32_32x32x16_bf16 v[176:191], v[196:199], a[160:163], v[176:191]
s_waitcnt lgkmcnt(10)
v_mfma_f32_32x32x16_bf16 v[160:175], v[200:203], a[164:167], v[160:175]
s_add_u32 s3, s32, 3177472
buffer_load_dwordx4 v239, s[16:19], s3 offen offset:1024 lds
s_waitcnt lgkmcnt(8)
v_mfma_f32_32x32x16_bf16 v[176:191], v[204:207], a[164:167], v[176:191]
s_add_u32 s3, s32, 3209216
buffer_load_dwordx4 v239, s[16:19], s3 offen offset:2048 lds
s_waitcnt lgkmcnt(6)
v_mfma_f32_32x32x16_bf16 v[160:175], v[208:211], a[168:171], v[160:175]
s_add_u32 s3, s32, 3240960
buffer_load_dwordx4 v239, s[16:19], s3 offen offset:3072 lds
s_waitcnt lgkmcnt(4)
v_mfma_f32_32x32x16_bf16 v[176:191], v[212:215], a[168:171], v[176:191]
s_add_u32 m0, s33, s71
s_add_u32 s7, s30, 16384
buffer_load_dwordx4 v236, s[8:11], s7 offen offset:0 nt lds
s_waitcnt lgkmcnt(2)
v_mfma_f32_32x32x16_bf16 v[160:175], v[216:219], a[172:175], v[160:175]
v_xor_b32 v240, 64, v236
buffer_load_dwordx4 v240, s[8:11], s7 offen offset:1024 nt lds
s_waitcnt lgkmcnt(0)
v_mfma_f32_32x32x16_bf16 v[176:191], v[220:223], a[172:175], v[176:191]
v_xor_b32 v240, 128, v236
buffer_load_dwordx4 v240, s[8:11], s7 offen offset:2048 nt lds
v_xor_b32 v240, 192, v236
buffer_load_dwordx4 v240, s[8:11], s7 offen offset:3072 nt lds
s_add_u32 s33, s33, 16384
s_cmp_ge_u32 s33, 81920
s_cselect_b32 s33, 0, s33
v_add_u32 v228, 131072, v234
v_xor_b32 v229, 64, v228
s_waitcnt vmcnt(42)
s_barrier
ds_read_b128 a[176:179], v16 offset:24576
ds_read_b128 a[180:183], v17 offset:24576
ds_read_b128 a[184:187], v18 offset:24576
ds_read_b128 a[188:191], v19 offset:24576
ds_read_b64_tr_b16 v[192:193], v228 offset:0
ds_read_b64_tr_b16 v[194:195], v228 offset:1024
ds_read_b64_tr_b16 v[196:197], v229 offset:0
ds_read_b64_tr_b16 v[198:199], v229 offset:1024
ds_read_b64_tr_b16 v[200:201], v228 offset:4096
ds_read_b64_tr_b16 v[202:203], v228 offset:5120
ds_read_b64_tr_b16 v[204:205], v229 offset:4096
ds_read_b64_tr_b16 v[206:207], v229 offset:5120
ds_read_b64_tr_b16 v[208:209], v228 offset:8192
ds_read_b64_tr_b16 v[210:211], v228 offset:9216
ds_read_b64_tr_b16 v[212:213], v229 offset:8192
ds_read_b64_tr_b16 v[214:215], v229 offset:9216
ds_read_b64_tr_b16 v[216:217], v228 offset:12288
ds_read_b64_tr_b16 v[218:219], v228 offset:13312
ds_read_b64_tr_b16 v[220:221], v229 offset:12288
ds_read_b64_tr_b16 v[222:223], v229 offset:13312
s_waitcnt lgkmcnt(14)
v_mfma_f32_32x32x16_bf16 v[160:175], v[192:195], a[176:179], v[160:175]
s_add_u32 m0, s71, 114688
s_add_u32 s3, s32, 3670016
buffer_load_dwordx4 v239, s[16:19], s3 offen offset:0 lds
s_waitcnt lgkmcnt(12)
v_mfma_f32_32x32x16_bf16 v[176:191], v[196:199], a[176:179], v[176:191]
s_waitcnt lgkmcnt(10)
v_mfma_f32_32x32x16_bf16 v[160:175], v[200:203], a[180:183], v[160:175]
s_add_u32 s3, s32, 3701760
buffer_load_dwordx4 v239, s[16:19], s3 offen offset:1024 lds
s_waitcnt lgkmcnt(8)
v_mfma_f32_32x32x16_bf16 v[176:191], v[204:207], a[180:183], v[176:191]
s_waitcnt lgkmcnt(6)
v_mfma_f32_32x32x16_bf16 v[160:175], v[208:211], a[184:187], v[160:175]
s_add_u32 s3, s32, 3733504
buffer_load_dwordx4 v239, s[16:19], s3 offen offset:2048 lds
s_waitcnt lgkmcnt(4)
v_mfma_f32_32x32x16_bf16 v[176:191], v[212:215], a[184:187], v[176:191]
s_waitcnt lgkmcnt(2)
v_mfma_f32_32x32x16_bf16 v[160:175], v[216:219], a[188:191], v[160:175]
s_add_u32 s3, s32, 3765248
buffer_load_dwordx4 v239, s[16:19], s3 offen offset:3072 lds
s_waitcnt lgkmcnt(0)
v_mfma_f32_32x32x16_bf16 v[176:191], v[220:223], a[188:191], v[176:191]
v_add_u32 v228, 147456, v234
v_xor_b32 v229, 64, v228
s_waitcnt vmcnt(40)
s_barrier
ds_read_b128 a[192:195], v16 offset:32768
ds_read_b128 a[196:199], v17 offset:32768
ds_read_b128 a[200:203], v18 offset:32768
ds_read_b128 a[204:207], v19 offset:32768
ds_read_b64_tr_b16 v[192:193], v228 offset:0
ds_read_b64_tr_b16 v[194:195], v228 offset:1024
ds_read_b64_tr_b16 v[196:197], v229 offset:0
ds_read_b64_tr_b16 v[198:199], v229 offset:1024
ds_read_b64_tr_b16 v[200:201], v228 offset:4096
ds_read_b64_tr_b16 v[202:203], v228 offset:5120
ds_read_b64_tr_b16 v[204:205], v229 offset:4096
ds_read_b64_tr_b16 v[206:207], v229 offset:5120
ds_read_b64_tr_b16 v[208:209], v228 offset:8192
ds_read_b64_tr_b16 v[210:211], v228 offset:9216
ds_read_b64_tr_b16 v[212:213], v229 offset:8192
ds_read_b64_tr_b16 v[214:215], v229 offset:9216
ds_read_b64_tr_b16 v[216:217], v228 offset:12288
ds_read_b64_tr_b16 v[218:219], v228 offset:13312
ds_read_b64_tr_b16 v[220:221], v229 offset:12288
ds_read_b64_tr_b16 v[222:223], v229 offset:13312
s_waitcnt lgkmcnt(14)
v_mfma_f32_32x32x16_bf16 v[160:175], v[192:195], a[192:195], v[160:175]
s_add_u32 m0, s33, s71
s_add_u32 s7, s30, 32768
buffer_load_dwordx4 v236, s[8:11], s7 offen offset:0 nt lds
s_waitcnt lgkmcnt(12)
v_mfma_f32_32x32x16_bf16 v[176:191], v[196:199], a[192:195], v[176:191]
s_waitcnt lgkmcnt(10)
v_mfma_f32_32x32x16_bf16 v[160:175], v[200:203], a[196:199], v[160:175]
v_xor_b32 v240, 64, v236
buffer_load_dwordx4 v240, s[8:11], s7 offen offset:1024 nt lds
s_waitcnt lgkmcnt(8)
v_mfma_f32_32x32x16_bf16 v[176:191], v[204:207], a[196:199], v[176:191]
s_waitcnt lgkmcnt(6)
v_mfma_f32_32x32x16_bf16 v[160:175], v[208:211], a[200:203], v[160:175]
v_xor_b32 v240, 128, v236
buffer_load_dwordx4 v240, s[8:11], s7 offen offset:2048 nt lds
s_waitcnt lgkmcnt(4)
v_mfma_f32_32x32x16_bf16 v[176:191], v[212:215], a[200:203], v[176:191]
s_waitcnt lgkmcnt(2)
v_mfma_f32_32x32x16_bf16 v[160:175], v[216:219], a[204:207], v[160:175]
v_xor_b32 v240, 192, v236
buffer_load_dwordx4 v240, s[8:11], s7 offen offset:3072 nt lds
s_add_u32 s33, s33, 16384
s_cmp_ge_u32 s33, 81920
s_cselect_b32 s33, 0, s33
s_waitcnt lgkmcnt(0)
v_mfma_f32_32x32x16_bf16 v[176:191], v[220:223], a[204:207], v[176:191]
v_add_u32 v228, 81920, v234
v_xor_b32 v229, 64, v228
s_waitcnt vmcnt(16)
s_barrier
ds_read_b128 a[208:211], v16 offset:40960
ds_read_b128 a[212:215], v17 offset:40960
ds_read_b128 a[216:219], v18 offset:40960
ds_read_b128 a[220:223], v19 offset:40960
ds_read_b64_tr_b16 v[192:193], v228 offset:0
ds_read_b64_tr_b16 v[194:195], v228 offset:1024
ds_read_b64_tr_b16 v[196:197], v229 offset:0
ds_read_b64_tr_b16 v[198:199], v229 offset:1024
ds_read_b64_tr_b16 v[200:201], v228 offset:4096
ds_read_b64_tr_b16 v[202:203], v228 offset:5120
ds_read_b64_tr_b16 v[204:205], v229 offset:4096
ds_read_b64_tr_b16 v[206:207], v229 offset:5120
ds_read_b64_tr_b16 v[208:209], v228 offset:8192
ds_read_b64_tr_b16 v[210:211], v228 offset:9216
ds_read_b64_tr_b16 v[212:213], v229 offset:8192
ds_read_b64_tr_b16 v[214:215], v229 offset:9216
ds_read_b64_tr_b16 v[216:217], v228 offset:12288
ds_read_b64_tr_b16 v[218:219], v228 offset:13312
ds_read_b64_tr_b16 v[220:221], v229 offset:12288
ds_read_b64_tr_b16 v[222:223], v229 offset:13312
s_waitcnt lgkmcnt(14)
v_mfma_f32_32x32x16_bf16 v[160:175], v[192:195], a[208:211], v[160:175]
s_waitcnt lgkmcnt(12)
v_mfma_f32_32x32x16_bf16 v[176:191], v[196:199], a[208:211], v[176:191]
s_waitcnt lgkmcnt(10)
v_mfma_f32_32x32x16_bf16 v[160:175], v[200:203], a[212:215], v[160:175]
s_waitcnt lgkmcnt(8)
v_mfma_f32_32x32x16_bf16 v[176:191], v[204:207], a[212:215], v[176:191]
s_waitcnt lgkmcnt(6)
v_mfma_f32_32x32x16_bf16 v[160:175], v[208:211], a[216:219], v[160:175]
s_waitcnt lgkmcnt(4)
v_mfma_f32_32x32x16_bf16 v[176:191], v[212:215], a[216:219], v[176:191]
s_waitcnt lgkmcnt(2)
v_mfma_f32_32x32x16_bf16 v[160:175], v[216:219], a[220:223], v[160:175]
s_waitcnt lgkmcnt(0)
v_mfma_f32_32x32x16_bf16 v[176:191], v[220:223], a[220:223], v[176:191]
v_add_u32 v228, 98304, v234
v_xor_b32 v229, 64, v228
s_waitcnt vmcnt(12)
s_barrier
ds_read_b128 a[224:227], v16 offset:49152
ds_read_b128 a[228:231], v17 offset:49152
ds_read_b128 a[232:235], v18 offset:49152
ds_read_b128 a[236:239], v19 offset:49152
ds_read_b64_tr_b16 v[192:193], v228 offset:0
ds_read_b64_tr_b16 v[194:195], v228 offset:1024
ds_read_b64_tr_b16 v[196:197], v229 offset:0
ds_read_b64_tr_b16 v[198:199], v229 offset:1024
ds_read_b64_tr_b16 v[200:201], v228 offset:4096
ds_read_b64_tr_b16 v[202:203], v228 offset:5120
ds_read_b64_tr_b16 v[204:205], v229 offset:4096
ds_read_b64_tr_b16 v[206:207], v229 offset:5120
ds_read_b64_tr_b16 v[208:209], v228 offset:8192
ds_read_b64_tr_b16 v[210:211], v228 offset:9216
ds_read_b64_tr_b16 v[212:213], v229 offset:8192
ds_read_b64_tr_b16 v[214:215], v229 offset:9216
ds_read_b64_tr_b16 v[216:217], v228 offset:12288
ds_read_b64_tr_b16 v[218:219], v228 offset:13312
ds_read_b64_tr_b16 v[220:221], v229 offset:12288
ds_read_b64_tr_b16 v[222:223], v229 offset:13312
s_waitcnt lgkmcnt(14)
v_mfma_f32_32x32x16_bf16 v[160:175], v[192:195], a[224:227], v[160:175]
s_add_u32 m0, s34, s71
s_add_u32 s3, s32, 256
buffer_load_dwordx4 v239, s[16:19], s3 offen offset:0 lds
s_waitcnt lgkmcnt(12)
v_mfma_f32_32x32x16_bf16 v[176:191], v[196:199], a[224:227], v[176:191]
s_waitcnt lgkmcnt(10)
v_mfma_f32_32x32x16_bf16 v[160:175], v[200:203], a[228:231], v[160:175]
s_add_u32 s3, s32, 32000
buffer_load_dwordx4 v239, s[16:19], s3 offen offset:1024 lds
s_waitcnt lgkmcnt(8)
v_mfma_f32_32x32x16_bf16 v[176:191], v[204:207], a[228:231], v[176:191]
s_add_u32 s3, s32, 63744
buffer_load_dwordx4 v239, s[16:19], s3 offen offset:2048 lds
s_waitcnt lgkmcnt(6)
v_mfma_f32_32x32x16_bf16 v[160:175], v[208:211], a[232:235], v[160:175]
s_add_u32 s3, s32, 95488
buffer_load_dwordx4 v239, s[16:19], s3 offen offset:3072 lds
s_add_u32 s34, s34, 16384
s_cmp_ge_u32 s34, 131072
s_cselect_b32 s34, 81920, s34
s_waitcnt lgkmcnt(4)
v_mfma_f32_32x32x16_bf16 v[176:191], v[212:215], a[232:235], v[176:191]
s_add_u32 m0, s33, s71
s_add_u32 s7, s30, 49152
buffer_load_dwordx4 v236, s[8:11], s7 offen offset:0 nt lds
s_waitcnt lgkmcnt(2)
v_mfma_f32_32x32x16_bf16 v[160:175], v[216:219], a[236:239], v[160:175]
v_xor_b32 v240, 64, v236
buffer_load_dwordx4 v240, s[8:11], s7 offen offset:1024 nt lds
s_waitcnt lgkmcnt(0)
v_mfma_f32_32x32x16_bf16 v[176:191], v[220:223], a[236:239], v[176:191]
v_xor_b32 v240, 128, v236
buffer_load_dwordx4 v240, s[8:11], s7 offen offset:2048 nt lds
v_xor_b32 v240, 192, v236
buffer_load_dwordx4 v240, s[8:11], s7 offen offset:3072 nt lds
s_add_u32 s33, s33, 16384
s_cmp_ge_u32 s33, 81920
s_cselect_b32 s33, 0, s33
v_add_u32 v228, 114688, v234
v_xor_b32 v229, 64, v228
s_waitcnt vmcnt(12)
s_barrier
ds_read_b128 a[240:243], v16 offset:57344
ds_read_b128 a[244:247], v17 offset:57344
ds_read_b128 a[248:251], v18 offset:57344
ds_read_b128 a[252:255], v19 offset:57344
ds_read_b64_tr_b16 v[192:193], v228 offset:0
ds_read_b64_tr_b16 v[194:195], v228 offset:1024
ds_read_b64_tr_b16 v[196:197], v229 offset:0
ds_read_b64_tr_b16 v[198:199], v229 offset:1024
ds_read_b64_tr_b16 v[200:201], v228 offset:4096
ds_read_b64_tr_b16 v[202:203], v228 offset:5120
ds_read_b64_tr_b16 v[204:205], v229 offset:4096
ds_read_b64_tr_b16 v[206:207], v229 offset:5120
ds_read_b64_tr_b16 v[208:209], v228 offset:8192
ds_read_b64_tr_b16 v[210:211], v228 offset:9216
ds_read_b64_tr_b16 v[212:213], v229 offset:8192
ds_read_b64_tr_b16 v[214:215], v229 offset:9216
ds_read_b64_tr_b16 v[216:217], v228 offset:12288
ds_read_b64_tr_b16 v[218:219], v228 offset:13312
ds_read_b64_tr_b16 v[220:221], v229 offset:12288
ds_read_b64_tr_b16 v[222:223], v229 offset:13312
s_waitcnt lgkmcnt(14)
v_mfma_f32_32x32x16_bf16 v[160:175], v[192:195], a[240:243], v[160:175]
s_add_u32 m0, s34, s71
s_add_u32 s3, s32, 524544
buffer_load_dwordx4 v239, s[16:19], s3 offen offset:0 lds
s_waitcnt lgkmcnt(12)
v_mfma_f32_32x32x16_bf16 v[176:191], v[196:199], a[240:243], v[176:191]
s_waitcnt lgkmcnt(10)
v_mfma_f32_32x32x16_bf16 v[160:175], v[200:203], a[244:247], v[160:175]
s_add_u32 s3, s32, 556288
buffer_load_dwordx4 v239, s[16:19], s3 offen offset:1024 lds
s_waitcnt lgkmcnt(8)
v_mfma_f32_32x32x16_bf16 v[176:191], v[204:207], a[244:247], v[176:191]
s_add_u32 s3, s32, 588032
buffer_load_dwordx4 v239, s[16:19], s3 offen offset:2048 lds
s_waitcnt lgkmcnt(6)
v_mfma_f32_32x32x16_bf16 v[160:175], v[208:211], a[248:251], v[160:175]
s_add_u32 s3, s32, 619776
buffer_load_dwordx4 v239, s[16:19], s3 offen offset:3072 lds
s_add_u32 s34, s34, 16384
s_cmp_ge_u32 s34, 131072
s_cselect_b32 s34, 81920, s34
s_waitcnt lgkmcnt(4)
v_mfma_f32_32x32x16_bf16 v[176:191], v[212:215], a[248:251], v[176:191]
buffer_load_dword v243, v238, s[20:23], s6 offen
s_waitcnt lgkmcnt(2)
v_mfma_f32_32x32x16_bf16 v[160:175], v[216:219], a[252:255], v[160:175]
buffer_load_dword v243, v238, s[20:23], s6 offen
s_waitcnt lgkmcnt(0)
v_mfma_f32_32x32x16_bf16 v[176:191], v[220:223], a[252:255], v[176:191]
buffer_load_dword v243, v238, s[20:23], s6 offen
buffer_load_dword v243, v238, s[20:23], s6 offen
s_add_u32 s32, s32, 256
s_add_u32 s60, s60, 16384
s_cmp_ge_u32 s60, 81920
s_cselect_b32 s60, 0, s60
v_add_u32 v224, s60, v232
s_add_u32 s61, s61, 16384
s_cmp_ge_u32 s61, 131072
s_cselect_b32 s61, 81920, s61
v_add_u32 v228, s61, v234
v_xor_b32 v229, 64, v228
s_nop 7
v_cvt_pk_bf16_f32 v128, v160, v161
v_cvt_pk_bf16_f32 v129, v162, v163
v_cvt_pk_bf16_f32 v130, v164, v165
v_cvt_pk_bf16_f32 v131, v166, v167
v_cvt_pk_bf16_f32 v132, v168, v169
v_cvt_pk_bf16_f32 v133, v170, v171
v_cvt_pk_bf16_f32 v134, v172, v173
v_cvt_pk_bf16_f32 v135, v174, v175
v_cvt_pk_bf16_f32 v136, v176, v177
v_cvt_pk_bf16_f32 v137, v178, v179
v_cvt_pk_bf16_f32 v138, v180, v181
v_cvt_pk_bf16_f32 v139, v182, v183
v_cvt_pk_bf16_f32 v140, v184, v185
v_cvt_pk_bf16_f32 v141, v186, v187
v_cvt_pk_bf16_f32 v142, v188, v189
v_cvt_pk_bf16_f32 v143, v190, v191
ds_write_b128 v241, v[128:131] offset:4096
ds_write_b128 v241, v[132:135] offset:5120
ds_write_b128 v241, v[136:139] offset:6144
ds_write_b128 v241, v[140:143] offset:7168
v_mov_b32 v160, 0
v_mov_b32 v161, 0
v_mov_b32 v162, 0
v_mov_b32 v163, 0
v_mov_b32 v164, 0
v_mov_b32 v165, 0
v_mov_b32 v166, 0
v_mov_b32 v167, 0
v_mov_b32 v168, 0
v_mov_b32 v169, 0
v_mov_b32 v170, 0
v_mov_b32 v171, 0
v_mov_b32 v172, 0
v_mov_b32 v173, 0
v_mov_b32 v174, 0
v_mov_b32 v175, 0
v_mov_b32 v176, 0
v_mov_b32 v177, 0
v_mov_b32 v178, 0
v_mov_b32 v179, 0
v_mov_b32 v180, 0
v_mov_b32 v181, 0
v_mov_b32 v182, 0
v_mov_b32 v183, 0
v_mov_b32 v184, 0
v_mov_b32 v185, 0
v_mov_b32 v186, 0
v_mov_b32 v187, 0
v_mov_b32 v188, 0
v_mov_b32 v189, 0
v_mov_b32 v190, 0
v_mov_b32 v191, 0
s_waitcnt lgkmcnt(0)
s_waitcnt vmcnt(50)
s_barrier
ds_read_b128 v[128:131], v242 offset:4096
ds_read_b128 v[132:135], v242 offset:5120
ds_read_b128 v[136:139], v242 offset:6144
ds_read_b128 v[140:143], v242 offset:7168
ds_read_b128 v[144:147], v242 offset:20480
ds_read_b128 v[148:151], v242 offset:21504
ds_read_b128 v[152:155], v242 offset:22528
ds_read_b128 v[156:159], v242 offset:23552
ds_read_b128 v[192:195], v224
v_xor_b32 v226, 32, v224
ds_read_b128 v[196:199], v226
v_xor_b32 v225, 64, v224
ds_read_b128 v[200:203], v225
v_xor_b32 v226, 96, v224
ds_read_b128 v[204:207], v226
v_xor_b32 v225, 128, v224
ds_read_b128 v[208:211], v225
v_xor_b32 v226, 160, v224
ds_read_b128 v[212:215], v226
v_xor_b32 v225, 192, v224
ds_read_b128 v[216:219], v225
v_xor_b32 v226, 224, v224
ds_read_b128 v[220:223], v226
s_waitcnt lgkmcnt(0)
L_head:
s_waitcnt vmcnt(12)
s_barrier
v_xor_b32 v240, 0x4000, v241
ds_write_b128 v240, v[160:163] offset:0
ds_write_b128 v240, v[164:167] offset:1024
ds_write_b128 v240, v[168:171] offset:2048
ds_write_b128 v240, v[172:175] offset:3072
ds_write_b128 v240, v[176:179] offset:4096
ds_write_b128 v240, v[180:183] offset:5120
ds_write_b128 v240, v[184:187] offset:6144
ds_write_b128 v240, v[188:191] offset:7168
s_waitcnt lgkmcnt(14)
v_mfma_f32_32x32x16_bf16 v[0:15], v[192:195], v[128:131], 0
ds_read_b64_tr_b16 v[192:193], v228 offset:0
ds_read_b64_tr_b16 v[194:195], v228 offset:1024
s_add_u32 m0, s34, s71
s_add_u32 s3, s32, 1048576
buffer_load_dwordx4 v239, s[16:19], s3 offen offset:0 lds
v_max_f32 v251, v252, v254
v_mfma_f32_32x32x16_bf16 v[0:15], v[196:199], v[132:135], v[0:15]
ds_read_b64_tr_b16 v[196:197], v229 offset:0
ds_read_b64_tr_b16 v[198:199], v229 offset:1024
v_sub_f32 v252, v252, v251
s_waitcnt lgkmcnt(15)
v_mfma_f32_32x32x16_bf16 v[0:15], v[200:203], v[136:139], v[0:15]
ds_read_b64_tr_b16 v[200:201], v228 offset:4096
ds_read_b64_tr_b16 v[202:203], v228 offset:5120
s_add_u32 s3, s32, 1080320
buffer_load_dwordx4 v239, s[16:19], s3 offen offset:1024 lds
v_sub_f32 v254, v254, v251
v_mfma_f32_32x32x16_bf16 v[0:15], v[204:207], v[140:143], v[0:15]
ds_read_b64_tr_b16 v[204:205], v229 offset:4096
ds_read_b64_tr_b16 v[206:207], v229 offset:5120
v_exp_f32 v252, v252
s_waitcnt lgkmcnt(15)
v_mfma_f32_32x32x16_bf16 v[0:15], v[208:211], v[144:147], v[0:15]
ds_read_b64_tr_b16 v[208:209], v228 offset:8192
ds_read_b64_tr_b16 v[210:211], v228 offset:9216
s_add_u32 s3, s32, 1112064
buffer_load_dwordx4 v239, s[16:19], s3 offen offset:2048 lds
v_exp_f32 v254, v254
v_mfma_f32_32x32x16_bf16 v[0:15], v[212:215], v[148:151], v[0:15]
ds_read_b64_tr_b16 v[212:213], v229 offset:8192
ds_read_b64_tr_b16 v[214:215], v229 offset:9216
s_nop 0
s_waitcnt lgkmcnt(15)
v_mfma_f32_32x32x16_bf16 v[0:15], v[216:219], v[152:155], v[0:15]
ds_read_b64_tr_b16 v[216:217], v228 offset:12288
ds_read_b64_tr_b16 v[218:219], v228 offset:13312
s_add_u32 s3, s32, 1143808
buffer_load_dwordx4 v239, s[16:19], s3 offen offset:3072 lds
v_mul_f32 v253, v253, v252
v_mfma_f32_32x32x16_bf16 v[0:15], v[220:223], v[156:159], v[0:15]
ds_read_b64_tr_b16 v[220:221], v229 offset:12288
ds_read_b64_tr_b16 v[222:223], v229 offset:13312
s_mov_b32 s35, s60
s_add_u32 s60, s60, 16384
s_cmp_ge_u32 s60, 81920
s_cselect_b32 s60, 0, s60
v_add_u32 v224, s60, v232
s_mov_b32 s34, s61
s_add_u32 s61, s61, 16384
s_cmp_ge_u32 s61, 131072
s_cselect_b32 s61, 81920, s61
v_add_u32 v228, s61, v234
v_xor_b32 v229, 64, v228
v_fma_f32 v253, v255, v254, v253
s_waitcnt lgkmcnt(12)
v_mfma_f32_32x32x16_bf16 v[160:175], v[192:195], a[128:131], 0
ds_read_b128 v[192:195], v224
s_add_u32 m0, s33, s71
s_add_u32 s7, s30, 65536
buffer_load_dwordx4 v236, s[8:11], s7 offen offset:0 nt lds
v_rcp_f32 v253, v253
v_mfma_f32_32x32x16_bf16 v[176:191], v[196:199], a[128:131], 0
v_xor_b32 v226, 32, v224
ds_read_b128 v[196:199], v226
s_nop 0
s_waitcnt lgkmcnt(10)
v_mfma_f32_32x32x16_bf16 v[160:175], v[200:203], a[132:135], v[160:175]
v_xor_b32 v225, 64, v224
ds_read_b128 v[200:203], v225
v_xor_b32 v240, 64, v236
buffer_load_dwordx4 v240, s[8:11], s7 offen offset:1024 nt lds
v_mul_f32 v252, v252, v253
v_mfma_f32_32x32x16_bf16 v[176:191], v[204:207], a[132:135], v[176:191]
v_xor_b32 v226, 96, v224
ds_read_b128 v[204:207], v226
v_mul_f32 v253, v254, v253
s_waitcnt lgkmcnt(8)
v_mfma_f32_32x32x16_bf16 v[160:175], v[208:211], a[136:139], v[160:175]
v_xor_b32 v225, 128, v224
ds_read_b128 v[208:211], v225
v_xor_b32 v240, 128, v236
buffer_load_dwordx4 v240, s[8:11], s7 offen offset:2048 nt lds
v_mfma_f32_32x32x16_bf16 v[176:191], v[212:215], a[136:139], v[176:191]
v_xor_b32 v226, 160, v224
ds_read_b128 v[212:215], v226
s_waitcnt lgkmcnt(6)
v_mfma_f32_32x32x16_bf16 v[160:175], v[216:219], a[140:143], v[160:175]
v_xor_b32 v225, 192, v224
ds_read_b128 v[216:219], v225
v_xor_b32 v240, 192, v236
buffer_load_dwordx4 v240, s[8:11], s7 offen offset:3072 nt lds
s_mov_b32 s33, s35
v_mfma_f32_32x32x16_bf16 v[176:191], v[220:223], a[140:143], v[176:191]
v_xor_b32 v226, 224, v224
ds_read_b128 v[220:223], v226
s_waitcnt vmcnt(12)
s_barrier
ds_read_b128 v[64:67], v241 offset:0
ds_read_b128 v[68:71], v241 offset:1024
ds_read_b128 v[72:75], v241 offset:2048
ds_read_b128 v[76:79], v241 offset:3072
ds_read_b128 v[80:83], v241 offset:4096
ds_read_b128 v[84:87], v241 offset:5120
ds_read_b128 v[88:91], v241 offset:6144
ds_read_b128 v[92:95], v241 offset:7168
s_waitcnt lgkmcnt(14)
v_mfma_f32_32x32x16_bf16 v[16:31], v[192:195], v[128:131], 0
ds_read_b64_tr_b16 v[192:193], v228 offset:0
ds_read_b64_tr_b16 v[194:195], v228 offset:1024
s_add_u32 m0, s34, s71
s_add_u32 s3, s32, 1572864
buffer_load_dwordx4 v239, s[16:19], s3 offen offset:0 lds
v_max_f32 v248, v0, v1
v_max3_f32 v248, v248, v2, v3
v_max3_f32 v248, v248, v4, v5
v_max3_f32 v248, v248, v6, v7
v_mfma_f32_32x32x16_bf16 v[16:31], v[196:199], v[132:135], v[16:31]
ds_read_b64_tr_b16 v[196:197], v229 offset:0
ds_read_b64_tr_b16 v[198:199], v229 offset:1024
v_max3_f32 v248, v248, v8, v9
v_max3_f32 v248, v248, v10, v11
v_max3_f32 v248, v248, v12, v13
v_max3_f32 v248, v248, v14, v15
s_waitcnt lgkmcnt(15)
v_mfma_f32_32x32x16_bf16 v[16:31], v[200:203], v[136:139], v[16:31]
ds_read_b64_tr_b16 v[200:201], v228 offset:4096
ds_read_b64_tr_b16 v[202:203], v228 offset:5120
s_add_u32 s3, s32, 1604608
buffer_load_dwordx4 v239, s[16:19], s3 offen offset:1024 lds
v_mfma_f32_32x32x16_bf16 v[16:31], v[204:207], v[140:143], v[16:31]
ds_read_b64_tr_b16 v[204:205], v229 offset:4096
ds_read_b64_tr_b16 v[206:207], v229 offset:5120
s_waitcnt lgkmcnt(15)
v_mfma_f32_32x32x16_bf16 v[16:31], v[208:211], v[144:147], v[16:31]
ds_read_b64_tr_b16 v[208:209], v228 offset:8192
ds_read_b64_tr_b16 v[210:211], v228 offset:9216
s_add_u32 s3, s32, 1636352
buffer_load_dwordx4 v239, s[16:19], s3 offen offset:2048 lds
v_mfma_f32_32x32x16_bf16 v[16:31], v[212:215], v[148:151], v[16:31]
ds_read_b64_tr_b16 v[212:213], v229 offset:8192
ds_read_b64_tr_b16 v[214:215], v229 offset:9216
s_waitcnt lgkmcnt(15)
v_mfma_f32_32x32x16_bf16 v[16:31], v[216:219], v[152:155], v[16:31]
ds_read_b64_tr_b16 v[216:217], v228 offset:12288
ds_read_b64_tr_b16 v[218:219], v228 offset:13312
s_add_u32 s3, s32, 1668096
buffer_load_dwordx4 v239, s[16:19], s3 offen offset:3072 lds
v_mfma_f32_32x32x16_bf16 v[16:31], v[220:223], v[156:159], v[16:31]
ds_read_b64_tr_b16 v[220:221], v229 offset:12288
ds_read_b64_tr_b16 v[222:223], v229 offset:13312
s_mov_b32 s35, s60
s_add_u32 s60, s60, 16384
s_cmp_ge_u32 s60, 81920
s_cselect_b32 s60, 0, s60
v_add_u32 v224, s60, v232
s_mov_b32 s34, s61
s_add_u32 s61, s61, 16384
s_cmp_ge_u32 s61, 131072
s_cselect_b32 s61, 81920, s61
v_add_u32 v228, s61, v234
v_xor_b32 v229, 64, v228
s_waitcnt lgkmcnt(12)
v_mfma_f32_32x32x16_bf16 v[160:175], v[192:195], a[144:147], v[160:175]
ds_read_b128 v[192:195], v224
s_add_u32 m0, s33, s71
s_add_u32 s7, s30, 81920
buffer_load_dwordx4 v236, s[8:11], s7 offen offset:0 nt lds
v_mul_f32 v32, v32, v252
v_fma_f32 v32, v64, v253, v32
v_mul_f32 v33, v33, v252
v_fma_f32 v33, v65, v253, v33
v_cvt_pk_bf16_f32 v96, v32, v33
v_mul_f32 v34, v34, v252
v_mfma_f32_32x32x16_bf16 v[176:191], v[196:199], a[144:147], v[176:191]
v_xor_b32 v226, 32, v224
ds_read_b128 v[196:199], v226
v_fma_f32 v34, v66, v253, v34
v_mul_f32 v35, v35, v252
v_fma_f32 v35, v67, v253, v35
v_cvt_pk_bf16_f32 v97, v34, v35
v_mul_f32 v36, v36, v252
v_fma_f32 v36, v68, v253, v36
s_waitcnt lgkmcnt(10)
v_mfma_f32_32x32x16_bf16 v[160:175], v[200:203], a[148:151], v[160:175]
v_xor_b32 v225, 64, v224
ds_read_b128 v[200:203], v225
v_xor_b32 v240, 64, v236
buffer_load_dwordx4 v240, s[8:11], s7 offen offset:1024 nt lds
v_mul_f32 v37, v37, v252
v_fma_f32 v37, v69, v253, v37
v_cvt_pk_bf16_f32 v98, v36, v37
v_mul_f32 v38, v38, v252
v_fma_f32 v38, v70, v253, v38
v_mfma_f32_32x32x16_bf16 v[176:191], v[204:207], a[148:151], v[176:191]
v_xor_b32 v226, 96, v224
ds_read_b128 v[204:207], v226
v_mul_f32 v39, v39, v252
v_fma_f32 v39, v71, v253, v39
v_cvt_pk_bf16_f32 v99, v38, v39
ds_write_b128 v241, v[96:99] offset:0
v_mul_f32 v40, v40, v252
s_waitcnt lgkmcnt(9)
v_mfma_f32_32x32x16_bf16 v[160:175], v[208:211], a[152:155], v[160:175]
v_xor_b32 v225, 128, v224
ds_read_b128 v[208:211], v225
v_xor_b32 v240, 128, v236
buffer_load_dwordx4 v240, s[8:11], s7 offen offset:2048 nt lds
v_fma_f32 v40, v72, v253, v40
v_mul_f32 v41, v41, v252
v_fma_f32 v41, v73, v253, v41
v_cvt_pk_bf16_f32 v100, v40, v41
v_mul_f32 v42, v42, v252
v_mfma_f32_32x32x16_bf16 v[176:191], v[212:215], a[152:155], v[176:191]
v_xor_b32 v226, 160, v224
ds_read_b128 v[212:215], v226
v_fma_f32 v42, v74, v253, v42
v_mul_f32 v43, v43, v252
v_fma_f32 v43, v75, v253, v43
v_cvt_pk_bf16_f32 v101, v42, v43
v_mul_f32 v44, v44, v252
s_waitcnt lgkmcnt(7)
v_mfma_f32_32x32x16_bf16 v[160:175], v[216:219], a[156:159], v[160:175]
v_xor_b32 v225, 192, v224
ds_read_b128 v[216:219], v225
v_xor_b32 v240, 192, v236
buffer_load_dwordx4 v240, s[8:11], s7 offen offset:3072 nt lds
s_mov_b32 s33, s35
v_fma_f32 v44, v76, v253, v44
v_mul_f32 v45, v45, v252
v_fma_f32 v45, v77, v253, v45
v_cvt_pk_bf16_f32 v102, v44, v45
v_mul_f32 v46, v46, v252
v_mfma_f32_32x32x16_bf16 v[176:191], v[220:223], a[156:159], v[176:191]
v_xor_b32 v226, 224, v224
ds_read_b128 v[220:223], v226
v_fma_f32 v46, v78, v253, v46
v_mul_f32 v47, v47, v252
v_fma_f32 v47, v79, v253, v47
v_cvt_pk_bf16_f32 v103, v46, v47
ds_write_b128 v241, v[100:103] offset:1024
s_waitcnt vmcnt(12)
s_barrier
s_waitcnt lgkmcnt(8)
v_mfma_f32_32x32x16_bf16 v[32:47], v[192:195], v[128:131], 0
ds_read_b64_tr_b16 v[192:193], v228 offset:0
ds_read_b64_tr_b16 v[194:195], v228 offset:1024
s_add_u32 m0, s34, s71
s_add_u32 s3, s32, 2097152
buffer_load_dwordx4 v239, s[16:19], s3 offen offset:0 lds
v_mul_f32 v48, v48, v252
v_fma_f32 v48, v80, v253, v48
v_mul_f32 v49, v49, v252
v_fma_f32 v49, v81, v253, v49
v_mfma_f32_32x32x16_bf16 v[32:47], v[196:199], v[132:135], v[32:47]
ds_read_b64_tr_b16 v[196:197], v229 offset:0
ds_read_b64_tr_b16 v[198:199], v229 offset:1024
v_cvt_pk_bf16_f32 v104, v48, v49
v_mul_f32 v50, v50, v252
v_fma_f32 v50, v82, v253, v50
v_mul_f32 v51, v51, v252
s_waitcnt lgkmcnt(10)
v_mfma_f32_32x32x16_bf16 v[32:47], v[200:203], v[136:139], v[32:47]
ds_read_b64_tr_b16 v[200:201], v228 offset:4096
ds_read_b64_tr_b16 v[202:203], v228 offset:5120
s_add_u32 s3, s32, 2128896
buffer_load_dwordx4 v239, s[16:19], s3 offen offset:1024 lds
v_fma_f32 v51, v83, v253, v51
v_cvt_pk_bf16_f32 v105, v50, v51
v_mul_f32 v52, v52, v252
v_mfma_f32_32x32x16_bf16 v[32:47], v[204:207], v[140:143], v[32:47]
ds_read_b64_tr_b16 v[204:205], v229 offset:4096
ds_read_b64_tr_b16 v[206:207], v229 offset:5120
v_fma_f32 v52, v84, v253, v52
v_mul_f32 v53, v53, v252
v_fma_f32 v53, v85, v253, v53
s_waitcnt lgkmcnt(11)
v_mfma_f32_32x32x16_bf16 v[32:47], v[208:211], v[144:147], v[32:47]
ds_read_b64_tr_b16 v[208:209], v228 offset:8192
ds_read_b64_tr_b16 v[210:211], v228 offset:9216
s_add_u32 s3, s32, 2160640
buffer_load_dwordx4 v239, s[16:19], s3 offen offset:2048 lds
v_cvt_pk_bf16_f32 v106, v52, v53
v_mul_f32 v54, v54, v252
v_fma_f32 v54, v86, v253, v54
v_mfma_f32_32x32x16_bf16 v[32:47], v[212:215], v[148:151], v[32:47]
ds_read_b64_tr_b16 v[212:213], v229 offset:8192
ds_read_b64_tr_b16 v[214:215], v229 offset:9216
v_mul_f32 v55, v55, v252
v_fma_f32 v55, v87, v253, v55
v_cvt_pk_bf16_f32 v107, v54, v55
s_waitcnt lgkmcnt(13)
v_mfma_f32_32x32x16_bf16 v[32:47], v[216:219], v[152:155], v[32:47]
ds_read_b64_tr_b16 v[216:217], v228 offset:12288
ds_read_b64_tr_b16 v[218:219], v228 offset:13312
s_add_u32 s3, s32, 2192384
buffer_load_dwordx4 v239, s[16:19], s3 offen offset:3072 lds
ds_write_b128 v241, v[104:107] offset:2048
v_mul_f32 v56, v56, v252
v_fma_f32 v56, v88, v253, v56
v_mfma_f32_32x32x16_bf16 v[32:47], v[220:223], v[156:159], v[32:47]
ds_read_b64_tr_b16 v[220:221], v229 offset:12288
ds_read_b64_tr_b16 v[222:223], v229 offset:13312
s_mov_b32 s35, s60
s_add_u32 s60, s60, 16384
s_cmp_ge_u32 s60, 81920
s_cselect_b32 s60, 0, s60
v_add_u32 v224, s60, v232
s_mov_b32 s34, s61
s_add_u32 s61, s61, 16384
s_cmp_ge_u32 s61, 131072
s_cselect_b32 s61, 81920, s61
v_add_u32 v228, s61, v234
v_xor_b32 v229, 64, v228
v_mul_f32 v57, v57, v252
v_fma_f32 v57, v89, v253, v57
v_cvt_pk_bf16_f32 v108, v56, v57
s_waitcnt lgkmcnt(13)
v_mfma_f32_32x32x16_bf16 v[160:175], v[192:195], a[160:163], v[160:175]
ds_read_b128 v[192:195], v224
s_add_u32 m0, s33, s71
s_add_u32 s7, s30, 98304
buffer_load_dwordx4 v236, s[8:11], s7 offen offset:0 nt lds
v_mul_f32 v58, v58, v252
v_fma_f32 v58, v90, v253, v58
v_mul_f32 v59, v59, v252
v_mfma_f32_32x32x16_bf16 v[176:191], v[196:199], a[160:163], v[176:191]
v_xor_b32 v226, 32, v224
ds_read_b128 v[196:199], v226
v_fma_f32 v59, v91, v253, v59
v_cvt_pk_bf16_f32 v109, v58, v59
v_mul_f32 v60, v60, v252
s_waitcnt lgkmcnt(11)
v_mfma_f32_32x32x16_bf16 v[160:175], v[200:203], a[164:167], v[160:175]
v_xor_b32 v225, 64, v224
ds_read_b128 v[200:203], v225
v_xor_b32 v240, 64, v236
buffer_load_dwordx4 v240, s[8:11], s7 offen offset:1024 nt lds
v_fma_f32 v60, v92, v253, v60
v_mul_f32 v61, v61, v252
v_fma_f32 v61, v93, v253, v61
v_mfma_f32_32x32x16_bf16 v[176:191], v[204:207], a[164:167], v[176:191]
v_xor_b32 v226, 96, v224
ds_read_b128 v[204:207], v226
v_cvt_pk_bf16_f32 v110, v60, v61
v_mul_f32 v62, v62, v252
v_fma_f32 v62, v94, v253, v62
s_waitcnt lgkmcnt(9)
v_mfma_f32_32x32x16_bf16 v[160:175], v[208:211], a[168:171], v[160:175]
v_xor_b32 v225, 128, v224
ds_read_b128 v[208:211], v225
v_xor_b32 v240, 128, v236
buffer_load_dwordx4 v240, s[8:11], s7 offen offset:2048 nt lds
v_mul_f32 v63, v63, v252
v_fma_f32 v63, v95, v253, v63
v_cvt_pk_bf16_f32 v111, v62, v63
v_mfma_f32_32x32x16_bf16 v[176:191], v[212:215], a[168:171], v[176:191]
v_xor_b32 v226, 160, v224
ds_read_b128 v[212:215], v226
ds_write_b128 v241, v[108:111] offset:3072
v_max3_f32 v248, v248, v16, v17
v_max3_f32 v248, v248, v18, v19
s_waitcnt lgkmcnt(7)
v_mfma_f32_32x32x16_bf16 v[160:175], v[216:219], a[172:175], v[160:175]
v_xor_b32 v225, 192, v224
ds_read_b128 v[216:219], v225
v_xor_b32 v240, 192, v236
buffer_load_dwordx4 v240, s[8:11], s7 offen offset:3072 nt lds
s_mov_b32 s33, s35
v_max3_f32 v248, v248, v20, v21
v_max3_f32 v248, v248, v22, v23
v_max3_f32 v248, v248, v24, v25
v_mfma_f32_32x32x16_bf16 v[176:191], v[220:223], a[172:175], v[176:191]
v_xor_b32 v226, 224, v224
ds_read_b128 v[220:223], v226
v_max3_f32 v248, v248, v26, v27
v_max3_f32 v248, v248, v28, v29
v_max3_f32 v248, v248, v30, v31
s_waitcnt vmcnt(12)
s_barrier
s_waitcnt lgkmcnt(7)
v_mfma_f32_32x32x16_bf16 v[48:63], v[192:195], v[128:131], 0
ds_read_b64_tr_b16 v[192:193], v228 offset:0
ds_read_b64_tr_b16 v[194:195], v228 offset:1024
s_add_u32 m0, s34, s71
s_add_u32 s3, s32, 2621440
buffer_load_dwordx4 v239, s[16:19], s3 offen offset:0 lds
v_max3_f32 v248, v248, v32, v33
v_mfma_f32_32x32x16_bf16 v[48:63], v[196:199], v[132:135], v[48:63]
ds_read_b64_tr_b16 v[196:197], v229 offset:0
ds_read_b64_tr_b16 v[198:199], v229 offset:1024
v_max3_f32 v248, v248, v34, v35
s_waitcnt lgkmcnt(9)
v_mfma_f32_32x32x16_bf16 v[48:63], v[200:203], v[136:139], v[48:63]
ds_read_b64_tr_b16 v[200:201], v228 offset:4096
ds_read_b64_tr_b16 v[202:203], v228 offset:5120
s_add_u32 s3, s32, 2653184
buffer_load_dwordx4 v239, s[16:19], s3 offen offset:1024 lds
v_max3_f32 v248, v248, v36, v37
v_mfma_f32_32x32x16_bf16 v[48:63], v[204:207], v[140:143], v[48:63]
ds_read_b64_tr_b16 v[204:205], v229 offset:4096
ds_read_b64_tr_b16 v[206:207], v229 offset:5120
v_max3_f32 v248, v248, v38, v39
s_waitcnt lgkmcnt(11)
v_mfma_f32_32x32x16_bf16 v[48:63], v[208:211], v[144:147], v[48:63]
ds_read_b64_tr_b16 v[208:209], v228 offset:8192
ds_read_b64_tr_b16 v[210:211], v228 offset:9216
s_add_u32 s3, s32, 2684928
buffer_load_dwordx4 v239, s[16:19], s3 offen offset:2048 lds
v_max3_f32 v248, v248, v40, v41
v_mfma_f32_32x32x16_bf16 v[48:63], v[212:215], v[148:151], v[48:63]
ds_read_b64_tr_b16 v[212:213], v229 offset:8192
ds_read_b64_tr_b16 v[214:215], v229 offset:9216
v_max3_f32 v248, v248, v42, v43
s_waitcnt lgkmcnt(12)
v_mfma_f32_32x32x16_bf16 v[48:63], v[216:219], v[152:155], v[48:63]
ds_read_b64_tr_b16 v[216:217], v228 offset:12288
ds_read_b64_tr_b16 v[218:219], v228 offset:13312
s_add_u32 s3, s32, 2716672
buffer_load_dwordx4 v239, s[16:19], s3 offen offset:3072 lds
v_max3_f32 v248, v248, v44, v45
v_mfma_f32_32x32x16_bf16 v[48:63], v[220:223], v[156:159], v[48:63]
ds_read_b64_tr_b16 v[220:221], v229 offset:12288
ds_read_b64_tr_b16 v[222:223], v229 offset:13312
s_mov_b32 s35, s60
s_add_u32 s60, s60, 16384
s_cmp_ge_u32 s60, 81920
s_cselect_b32 s60, 0, s60
v_add_u32 v224, s60, v232
s_mov_b32 s34, s61
s_add_u32 s61, s61, 16384
s_cmp_ge_u32 s61, 131072
s_cselect_b32 s61, 81920, s61
v_add_u32 v228, s61, v234
v_xor_b32 v229, 64, v228
v_max3_f32 v248, v248, v46, v47
s_waitcnt lgkmcnt(12)
v_mfma_f32_32x32x16_bf16 v[160:175], v[192:195], a[176:179], v[160:175]
ds_read_b128 v[192:195], v224
s_add_u32 m0, s33, s71
s_add_u32 s7, s30, 114688
buffer_load_dwordx4 v236, s[8:11], s7 offen offset:0 nt lds
v_mfma_f32_32x32x16_bf16 v[176:191], v[196:199], a[176:179], v[176:191]
v_xor_b32 v226, 32, v224
ds_read_b128 v[196:199], v226
s_waitcnt lgkmcnt(10)
v_mfma_f32_32x32x16_bf16 v[160:175], v[200:203], a[180:183], v[160:175]
v_xor_b32 v225, 64, v224
ds_read_b128 v[200:203], v225
v_xor_b32 v240, 64, v236
buffer_load_dwordx4 v240, s[8:11], s7 offen offset:1024 nt lds
v_mfma_f32_32x32x16_bf16 v[176:191], v[204:207], a[180:183], v[176:191]
v_xor_b32 v226, 96, v224
ds_read_b128 v[204:207], v226
s_waitcnt lgkmcnt(8)
v_mfma_f32_32x32x16_bf16 v[160:175], v[208:211], a[184:187], v[160:175]
v_xor_b32 v225, 128, v224
ds_read_b128 v[208:211], v225
v_xor_b32 v240, 128, v236
buffer_load_dwordx4 v240, s[8:11], s7 offen offset:2048 nt lds
v_mfma_f32_32x32x16_bf16 v[176:191], v[212:215], a[184:187], v[176:191]
v_xor_b32 v226, 160, v224
ds_read_b128 v[212:215], v226
s_waitcnt lgkmcnt(6)
v_mfma_f32_32x32x16_bf16 v[160:175], v[216:219], a[188:191], v[160:175]
v_xor_b32 v225, 192, v224
ds_read_b128 v[216:219], v225
v_xor_b32 v240, 192, v236
buffer_load_dwordx4 v240, s[8:11], s7 offen offset:3072 nt lds
s_mov_b32 s33, s35
v_mfma_f32_32x32x16_bf16 v[176:191], v[220:223], a[188:191], v[176:191]
v_xor_b32 v226, 224, v224
ds_read_b128 v[220:223], v226
s_waitcnt vmcnt(12)
s_barrier
s_waitcnt lgkmcnt(6)
v_mfma_f32_32x32x16_bf16 v[64:79], v[192:195], v[128:131], 0
ds_read_b64_tr_b16 v[192:193], v228 offset:0
ds_read_b64_tr_b16 v[194:195], v228 offset:1024
s_add_u32 m0, s34, s71
s_add_u32 s3, s32, 3145728
buffer_load_dwordx4 v239, s[16:19], s3 offen offset:0 lds
v_max3_f32 v248, v248, v48, v49
v_max3_f32 v248, v248, v50, v51
v_max3_f32 v248, v248, v52, v53
v_max3_f32 v248, v248, v54, v55
v_max3_f32 v248, v248, v56, v57
v_max3_f32 v248, v248, v58, v59
v_mfma_f32_32x32x16_bf16 v[64:79], v[196:199], v[132:135], v[64:79]
ds_read_b64_tr_b16 v[196:197], v229 offset:0
ds_read_b64_tr_b16 v[198:199], v229 offset:1024
v_max3_f32 v248, v248, v60, v61
v_max3_f32 v248, v248, v62, v63
v_mov_b32 v251, v248
s_nop 1
v_permlane32_swap_b32 v248, v251
v_max_f32 v248, v248, v251
s_waitcnt lgkmcnt(8)
v_mfma_f32_32x32x16_bf16 v[64:79], v[200:203], v[136:139], v[64:79]
ds_read_b64_tr_b16 v[200:201], v228 offset:4096
ds_read_b64_tr_b16 v[202:203], v228 offset:5120
s_add_u32 s3, s32, 3177472
buffer_load_dwordx4 v239, s[16:19], s3 offen offset:1024 lds
v_mul_f32 v249, s62, v248
v_mov_b32 v250, 0
v_fma_f32 v0, v0, s62, -v249
v_fma_f32 v1, v1, s62, -v249
v_exp_f32 v0, v0
v_mfma_f32_32x32x16_bf16 v[64:79], v[204:207], v[140:143], v[64:79]
ds_read_b64_tr_b16 v[204:205], v229 offset:4096
ds_read_b64_tr_b16 v[206:207], v229 offset:5120
v_exp_f32 v1, v1
v_fma_f32 v2, v2, s62, -v249
v_fma_f32 v3, v3, s62, -v249
v_exp_f32 v2, v2
s_waitcnt lgkmcnt(10)
v_mfma_f32_32x32x16_bf16 v[64:79], v[208:211], v[144:147], v[64:79]
ds_read_b64_tr_b16 v[208:209], v228 offset:8192
ds_read_b64_tr_b16 v[210:211], v228 offset:9216
s_add_u32 s3, s32, 3209216
buffer_load_dwordx4 v239, s[16:19], s3 offen offset:2048 lds
v_exp_f32 v3, v3
v_add_f32 v250, v250, v0
v_add_f32 v250, v250, v1
v_cvt_pk_bf16_f32 v0, v0, v1
v_fma_f32 v4, v4, s62, -v249
v_mfma_f32_32x32x16_bf16 v[64:79], v[212:215], v[148:151], v[64:79]
ds_read_b64_tr_b16 v[212:213], v229 offset:8192
ds_read_b64_tr_b16 v[214:215], v229 offset:9216
v_fma_f32 v5, v5, s62, -v249
v_exp_f32 v4, v4
v_exp_f32 v5, v5
v_add_f32 v250, v250, v2
s_waitcnt lgkmcnt(12)
v_mfma_f32_32x32x16_bf16 v[64:79], v[216:219], v[152:155], v[64:79]
ds_read_b64_tr_b16 v[216:217], v228 offset:12288
ds_read_b64_tr_b16 v[218:219], v228 offset:13312
s_add_u32 s3, s32, 3240960
buffer_load_dwordx4 v239, s[16:19], s3 offen offset:3072 lds
v_add_f32 v250, v250, v3
v_cvt_pk_bf16_f32 v1, v2, v3
v_fma_f32 v6, v6, s62, -v249
v_fma_f32 v7, v7, s62, -v249
v_exp_f32 v6, v6
v_mfma_f32_32x32x16_bf16 v[64:79], v[220:223], v[156:159], v[64:79]
ds_read_b64_tr_b16 v[220:221], v229 offset:12288
ds_read_b64_tr_b16 v[222:223], v229 offset:13312
s_mov_b32 s35, s60
s_add_u32 s60, s60, 16384
s_cmp_ge_u32 s60, 81920
s_cselect_b32 s60, 0, s60
v_add_u32 v224, s60, v232
s_mov_b32 s34, s61
s_add_u32 s61, s61, 16384
s_cmp_ge_u32 s61, 131072
s_cselect_b32 s61, 81920, s61
v_add_u32 v228, s61, v234
v_xor_b32 v229, 64, v228
v_exp_f32 v7, v7
v_add_f32 v250, v250, v4
v_add_f32 v250, v250, v5
v_cvt_pk_bf16_f32 v2, v4, v5
s_waitcnt lgkmcnt(12)
v_mfma_f32_32x32x16_bf16 v[160:175], v[192:195], a[192:195], v[160:175]
ds_read_b128 v[192:195], v224
s_add_u32 m0, s33, s71
s_add_u32 s7, s30, 0
buffer_load_dwordx4 v237, s[12:15], s7 offen offset:0 nt lds
v_fma_f32 v8, v8, s62, -v249
v_fma_f32 v9, v9, s62, -v249
v_exp_f32 v8, v8
v_exp_f32 v9, v9
v_mfma_f32_32x32x16_bf16 v[176:191], v[196:199], a[192:195], v[176:191]
v_xor_b32 v226, 32, v224
ds_read_b128 v[196:199], v226
v_add_f32 v250, v250, v6
v_add_f32 v250, v250, v7
v_cvt_pk_bf16_f32 v3, v6, v7
v_fma_f32 v10, v10, s62, -v249
v_fma_f32 v11, v11, s62, -v249
s_waitcnt lgkmcnt(10)
v_mfma_f32_32x32x16_bf16 v[160:175], v[200:203], a[196:199], v[160:175]
v_xor_b32 v225, 64, v224
ds_read_b128 v[200:203], v225
buffer_load_dwordx4 v237, s[12:15], s7 offen offset:1024 nt lds
v_exp_f32 v10, v10
v_exp_f32 v11, v11
v_add_f32 v250, v250, v8
v_mfma_f32_32x32x16_bf16 v[176:191], v[204:207], a[196:199], v[176:191]
v_xor_b32 v226, 96, v224
ds_read_b128 v[204:207], v226
v_add_f32 v250, v250, v9
v_cvt_pk_bf16_f32 v4, v8, v9
v_fma_f32 v12, v12, s62, -v249
v_fma_f32 v13, v13, s62, -v249
v_exp_f32 v12, v12
s_waitcnt lgkmcnt(8)
v_mfma_f32_32x32x16_bf16 v[160:175], v[208:211], a[200:203], v[160:175]
v_xor_b32 v225, 128, v224
ds_read_b128 v[208:211], v225
buffer_load_dwordx4 v237, s[12:15], s7 offen offset:2048 nt lds
v_exp_f32 v13, v13
v_add_f32 v250, v250, v10
v_add_f32 v250, v250, v11
v_cvt_pk_bf16_f32 v5, v10, v11
v_mfma_f32_32x32x16_bf16 v[176:191], v[212:215], a[200:203], v[176:191]
v_xor_b32 v226, 160, v224
ds_read_b128 v[212:215], v226
v_fma_f32 v14, v14, s62, -v249
v_fma_f32 v15, v15, s62, -v249
v_exp_f32 v14, v14
v_exp_f32 v15, v15
s_waitcnt lgkmcnt(6)
v_mfma_f32_32x32x16_bf16 v[160:175], v[216:219], a[204:207], v[160:175]
v_xor_b32 v225, 192, v224
ds_read_b128 v[216:219], v225
buffer_load_dwordx4 v237, s[12:15], s7 offen offset:3072 nt lds
s_mov_b32 s33, s35
v_add_f32 v250, v250, v12
v_add_f32 v250, v250, v13
v_cvt_pk_bf16_f32 v6, v12, v13
s_nop 0
v_mfma_f32_32x32x16_bf16 v[176:191], v[220:223], a[204:207], v[176:191]
v_xor_b32 v226, 224, v224
ds_read_b128 v[220:223], v226
v_add_f32 v250, v250, v14
v_add_f32 v250, v250, v15
v_cvt_pk_bf16_f32 v7, v14, v15
s_waitcnt vmcnt(12)
s_barrier
s_waitcnt lgkmcnt(6)
v_mfma_f32_32x32x16_bf16 v[80:95], v[192:195], v[128:131], 0
ds_read_b64_tr_b16 v[192:193], v228 offset:0
ds_read_b64_tr_b16 v[194:195], v228 offset:1024
s_add_u32 m0, s34, s71
s_add_u32 s3, s32, 3670016
buffer_load_dwordx4 v239, s[16:19], s3 offen offset:0 lds
v_fma_f32 v16, v16, s62, -v249
v_fma_f32 v17, v17, s62, -v249
v_exp_f32 v16, v16
v_exp_f32 v17, v17
v_mfma_f32_32x32x16_bf16 v[80:95], v[196:199], v[132:135], v[80:95]
ds_read_b64_tr_b16 v[196:197], v229 offset:0
ds_read_b64_tr_b16 v[198:199], v229 offset:1024
v_fma_f32 v18, v18, s62, -v249
v_fma_f32 v19, v19, s62, -v249
v_exp_f32 v18, v18
v_exp_f32 v19, v19
s_waitcnt lgkmcnt(8)
v_mfma_f32_32x32x16_bf16 v[80:95], v[200:203], v[136:139], v[80:95]
ds_read_b64_tr_b16 v[200:201], v228 offset:4096
ds_read_b64_tr_b16 v[202:203], v228 offset:5120
s_add_u32 s3, s32, 3701760
buffer_load_dwordx4 v239, s[16:19], s3 offen offset:1024 lds
v_add_f32 v250, v250, v16
v_add_f32 v250, v250, v17
v_cvt_pk_bf16_f32 v8, v16, v17
v_fma_f32 v20, v20, s62, -v249
v_fma_f32 v21, v21, s62, -v249
v_mfma_f32_32x32x16_bf16 v[80:95], v[204:207], v[140:143], v[80:95]
ds_read_b64_tr_b16 v[204:205], v229 offset:4096
ds_read_b64_tr_b16 v[206:207], v229 offset:5120
v_exp_f32 v20, v20
v_exp_f32 v21, v21
v_add_f32 v250, v250, v18
s_waitcnt lgkmcnt(10)
v_mfma_f32_32x32x16_bf16 v[80:95], v[208:211], v[144:147], v[80:95]
ds_read_b64_tr_b16 v[208:209], v228 offset:8192
ds_read_b64_tr_b16 v[210:211], v228 offset:9216
s_add_u32 s3, s32, 3733504
buffer_load_dwordx4 v239, s[16:19], s3 offen offset:2048 lds
v_add_f32 v250, v250, v19
v_cvt_pk_bf16_f32 v9, v18, v19
v_fma_f32 v22, v22, s62, -v249
v_fma_f32 v23, v23, s62, -v249
v_exp_f32 v22, v22
v_mfma_f32_32x32x16_bf16 v[80:95], v[212:215], v[148:151], v[80:95]
ds_read_b64_tr_b16 v[212:213], v229 offset:8192
ds_read_b64_tr_b16 v[214:215], v229 offset:9216
v_exp_f32 v23, v23
v_add_f32 v250, v250, v20
v_add_f32 v250, v250, v21
v_cvt_pk_bf16_f32 v10, v20, v21
s_waitcnt lgkmcnt(12)
v_mfma_f32_32x32x16_bf16 v[80:95], v[216:219], v[152:155], v[80:95]
ds_read_b64_tr_b16 v[216:217], v228 offset:12288
ds_read_b64_tr_b16 v[218:219], v228 offset:13312
s_add_u32 s3, s32, 3765248
buffer_load_dwordx4 v239, s[16:19], s3 offen offset:3072 lds
v_fma_f32 v24, v24, s62, -v249
v_fma_f32 v25, v25, s62, -v249
v_exp_f32 v24, v24
v_exp_f32 v25, v25
v_mfma_f32_32x32x16_bf16 v[80:95], v[220:223], v[156:159], v[80:95]
ds_read_b64_tr_b16 v[220:221], v229 offset:12288
ds_read_b64_tr_b16 v[222:223], v229 offset:13312
s_mov_b32 s35, s60
s_add_u32 s60, s60, 16384
s_cmp_ge_u32 s60, 81920
s_cselect_b32 s60, 0, s60
v_add_u32 v224, s60, v232
s_mov_b32 s34, s61
s_add_u32 s61, s61, 16384
s_cmp_ge_u32 s61, 131072
s_cselect_b32 s61, 81920, s61
v_add_u32 v228, s61, v234
v_xor_b32 v229, 64, v228
v_add_f32 v250, v250, v22
v_add_f32 v250, v250, v23
v_cvt_pk_bf16_f32 v11, v22, v23
v_fma_f32 v26, v26, s62, -v249
v_fma_f32 v27, v27, s62, -v249
s_waitcnt lgkmcnt(12)
v_mfma_f32_32x32x16_bf16 v[160:175], v[192:195], a[208:211], v[160:175]
ds_read_b128 v[192:195], v224
s_add_u32 m0, s33, s71
s_add_u32 s7, s30, 16384
buffer_load_dwordx4 v237, s[12:15], s7 offen offset:0 nt lds
v_exp_f32 v26, v26
v_exp_f32 v27, v27
v_add_f32 v250, v250, v24
v_mfma_f32_32x32x16_bf16 v[176:191], v[196:199], a[208:211], v[176:191]
v_xor_b32 v226, 32, v224
ds_read_b128 v[196:199], v226
v_add_f32 v250, v250, v25
v_cvt_pk_bf16_f32 v12, v24, v25
v_fma_f32 v28, v28, s62, -v249
v_fma_f32 v29, v29, s62, -v249
v_exp_f32 v28, v28
s_waitcnt lgkmcnt(10)
v_mfma_f32_32x32x16_bf16 v[160:175], v[200:203], a[212:215], v[160:175]
v_xor_b32 v225, 64, v224
ds_read_b128 v[200:203], v225
buffer_load_dwordx4 v237, s[12:15], s7 offen offset:1024 nt lds
v_exp_f32 v29, v29
v_add_f32 v250, v250, v26
v_add_f32 v250, v250, v27
v_cvt_pk_bf16_f32 v13, v26, v27
v_mfma_f32_32x32x16_bf16 v[176:191], v[204:207], a[212:215], v[176:191]
v_xor_b32 v226, 96, v224
ds_read_b128 v[204:207], v226
v_fma_f32 v30, v30, s62, -v249
v_fma_f32 v31, v31, s62, -v249
v_exp_f32 v30, v30
v_exp_f32 v31, v31
s_waitcnt lgkmcnt(8)
v_mfma_f32_32x32x16_bf16 v[160:175], v[208:211], a[216:219], v[160:175]
v_xor_b32 v225, 128, v224
ds_read_b128 v[208:211], v225
buffer_load_dwordx4 v237, s[12:15], s7 offen offset:2048 nt lds
v_add_f32 v250, v250, v28
v_add_f32 v250, v250, v29
v_cvt_pk_bf16_f32 v14, v28, v29
s_nop 0
v_mfma_f32_32x32x16_bf16 v[176:191], v[212:215], a[216:219], v[176:191]
v_xor_b32 v226, 160, v224
ds_read_b128 v[212:215], v226
v_add_f32 v250, v250, v30
v_add_f32 v250, v250, v31
v_cvt_pk_bf16_f32 v15, v30, v31
v_max3_f32 v248, v248, v64, v65
s_waitcnt lgkmcnt(6)
v_mfma_f32_32x32x16_bf16 v[160:175], v[216:219], a[220:223], v[160:175]
v_xor_b32 v225, 192, v224
ds_read_b128 v[216:219], v225
buffer_load_dwordx4 v237, s[12:15], s7 offen offset:3072 nt lds
s_mov_b32 s33, s35
v_max3_f32 v248, v248, v66, v67
v_max3_f32 v248, v248, v68, v69
v_max3_f32 v248, v248, v70, v71
v_max3_f32 v248, v248, v72, v73
v_mfma_f32_32x32x16_bf16 v[176:191], v[220:223], a[220:223], v[176:191]
v_xor_b32 v226, 224, v224
ds_read_b128 v[220:223], v226
v_max3_f32 v248, v248, v74, v75
v_max3_f32 v248, v248, v76, v77
v_max3_f32 v248, v248, v78, v79
s_waitcnt vmcnt(12)
s_barrier
s_waitcnt lgkmcnt(6)
v_mfma_f32_32x32x16_bf16 v[96:111], v[192:195], v[128:131], 0
ds_read_b64_tr_b16 v[192:193], v228 offset:0
ds_read_b64_tr_b16 v[194:195], v228 offset:1024
s_add_u32 m0, s34, s71
s_add_u32 s3, s31, 0
buffer_load_dwordx4 v238, s[20:23], s3 offen offset:0 lds
v_fma_f32 v32, v32, s62, -v249
v_fma_f32 v33, v33, s62, -v249
v_exp_f32 v32, v32
v_exp_f32 v33, v33
v_mfma_f32_32x32x16_bf16 v[96:111], v[196:199], v[132:135], v[96:111]
ds_read_b64_tr_b16 v[196:197], v229 offset:0
ds_read_b64_tr_b16 v[198:199], v229 offset:1024
v_fma_f32 v34, v34, s62, -v249
v_fma_f32 v35, v35, s62, -v249
v_exp_f32 v34, v34
v_exp_f32 v35, v35
s_waitcnt lgkmcnt(8)
v_mfma_f32_32x32x16_bf16 v[96:111], v[200:203], v[136:139], v[96:111]
ds_read_b64_tr_b16 v[200:201], v228 offset:4096
ds_read_b64_tr_b16 v[202:203], v228 offset:5120
v_xor_b32 v240, 64, v238
buffer_load_dwordx4 v240, s[20:23], s3 offen offset:1024 lds
v_add_f32 v250, v250, v32
v_add_f32 v250, v250, v33
v_cvt_pk_bf16_f32 v16, v32, v33
v_fma_f32 v36, v36, s62, -v249
v_fma_f32 v37, v37, s62, -v249
v_mfma_f32_32x32x16_bf16 v[96:111], v[204:207], v[140:143], v[96:111]
ds_read_b64_tr_b16 v[204:205], v229 offset:4096
ds_read_b64_tr_b16 v[206:207], v229 offset:5120
v_exp_f32 v36, v36
v_exp_f32 v37, v37
v_add_f32 v250, v250, v34
s_waitcnt lgkmcnt(10)
v_mfma_f32_32x32x16_bf16 v[96:111], v[208:211], v[144:147], v[96:111]
ds_read_b64_tr_b16 v[208:209], v228 offset:8192
ds_read_b64_tr_b16 v[210:211], v228 offset:9216
v_xor_b32 v240, 128, v238
buffer_load_dwordx4 v240, s[20:23], s3 offen offset:2048 lds
v_add_f32 v250, v250, v35
v_cvt_pk_bf16_f32 v17, v34, v35
v_fma_f32 v38, v38, s62, -v249
v_fma_f32 v39, v39, s62, -v249
v_exp_f32 v38, v38
v_mfma_f32_32x32x16_bf16 v[96:111], v[212:215], v[148:151], v[96:111]
ds_read_b64_tr_b16 v[212:213], v229 offset:8192
ds_read_b64_tr_b16 v[214:215], v229 offset:9216
v_exp_f32 v39, v39
v_add_f32 v250, v250, v36
v_add_f32 v250, v250, v37
v_cvt_pk_bf16_f32 v18, v36, v37
s_waitcnt lgkmcnt(12)
v_mfma_f32_32x32x16_bf16 v[96:111], v[216:219], v[152:155], v[96:111]
ds_read_b64_tr_b16 v[216:217], v228 offset:12288
ds_read_b64_tr_b16 v[218:219], v228 offset:13312
v_xor_b32 v240, 192, v238
buffer_load_dwordx4 v240, s[20:23], s3 offen offset:3072 lds
v_fma_f32 v40, v40, s62, -v249
v_fma_f32 v41, v41, s62, -v249
v_exp_f32 v40, v40
v_exp_f32 v41, v41
v_mfma_f32_32x32x16_bf16 v[96:111], v[220:223], v[156:159], v[96:111]
ds_read_b64_tr_b16 v[220:221], v229 offset:12288
ds_read_b64_tr_b16 v[222:223], v229 offset:13312
s_mov_b32 s35, s60
s_add_u32 s60, s60, 16384
s_cmp_ge_u32 s60, 81920
s_cselect_b32 s60, 0, s60
v_add_u32 v224, s60, v232
s_mov_b32 s34, s61
s_add_u32 s61, s61, 16384
s_cmp_ge_u32 s61, 131072
s_cselect_b32 s61, 81920, s61
v_add_u32 v228, s61, v234
v_xor_b32 v229, 64, v228
v_add_f32 v250, v250, v38
v_add_f32 v250, v250, v39
v_cvt_pk_bf16_f32 v19, v38, v39
v_fma_f32 v42, v42, s62, -v249
v_fma_f32 v43, v43, s62, -v249
s_waitcnt lgkmcnt(12)
v_mfma_f32_32x32x16_bf16 v[160:175], v[192:195], a[224:227], v[160:175]
ds_read_b128 v[192:195], v224
s_add_u32 m0, s33, s71
s_add_u32 s7, s30, 32768
buffer_load_dwordx4 v237, s[12:15], s7 offen offset:0 nt lds
v_exp_f32 v42, v42
v_exp_f32 v43, v43
v_add_f32 v250, v250, v40
v_mfma_f32_32x32x16_bf16 v[176:191], v[196:199], a[224:227], v[176:191]
v_xor_b32 v226, 32, v224
ds_read_b128 v[196:199], v226
v_add_f32 v250, v250, v41
v_cvt_pk_bf16_f32 v20, v40, v41
v_fma_f32 v44, v44, s62, -v249
v_fma_f32 v45, v45, s62, -v249
v_exp_f32 v44, v44
s_waitcnt lgkmcnt(10)
v_mfma_f32_32x32x16_bf16 v[160:175], v[200:203], a[228:231], v[160:175]
v_xor_b32 v225, 64, v224
ds_read_b128 v[200:203], v225
buffer_load_dwordx4 v237, s[12:15], s7 offen offset:1024 nt lds
v_exp_f32 v45, v45
v_add_f32 v250, v250, v42
v_add_f32 v250, v250, v43
v_cvt_pk_bf16_f32 v21, v42, v43
v_mfma_f32_32x32x16_bf16 v[176:191], v[204:207], a[228:231], v[176:191]
v_xor_b32 v226, 96, v224
ds_read_b128 v[204:207], v226
v_fma_f32 v46, v46, s62, -v249
v_fma_f32 v47, v47, s62, -v249
v_exp_f32 v46, v46
v_exp_f32 v47, v47
s_waitcnt lgkmcnt(8)
v_mfma_f32_32x32x16_bf16 v[160:175], v[208:211], a[232:235], v[160:175]
v_xor_b32 v225, 128, v224
ds_read_b128 v[208:211], v225
buffer_load_dwordx4 v237, s[12:15], s7 offen offset:2048 nt lds
v_add_f32 v250, v250, v44
v_add_f32 v250, v250, v45
v_cvt_pk_bf16_f32 v22, v44, v45
s_nop 0
v_mfma_f32_32x32x16_bf16 v[176:191], v[212:215], a[232:235], v[176:191]
v_xor_b32 v226, 160, v224
ds_read_b128 v[212:215], v226
v_add_f32 v250, v250, v46
v_add_f32 v250, v250, v47
v_cvt_pk_bf16_f32 v23, v46, v47
v_max3_f32 v248, v248, v80, v81
s_waitcnt lgkmcnt(6)
v_mfma_f32_32x32x16_bf16 v[160:175], v[216:219], a[236:239], v[160:175]
v_xor_b32 v225, 192, v224
ds_read_b128 v[216:219], v225
buffer_load_dwordx4 v237, s[12:15], s7 offen offset:3072 nt lds
s_mov_b32 s33, s35
v_max3_f32 v248, v248, v82, v83
v_max3_f32 v248, v248, v84, v85
v_max3_f32 v248, v248, v86, v87
v_max3_f32 v248, v248, v88, v89
v_mfma_f32_32x32x16_bf16 v[176:191], v[220:223], a[236:239], v[176:191]
v_xor_b32 v226, 224, v224
ds_read_b128 v[220:223], v226
v_max3_f32 v248, v248, v90, v91
v_max3_f32 v248, v248, v92, v93
v_max3_f32 v248, v248, v94, v95
s_waitcnt vmcnt(12)
s_barrier
s_waitcnt lgkmcnt(6)
v_mfma_f32_32x32x16_bf16 v[112:127], v[192:195], v[128:131], 0
ds_read_b64_tr_b16 v[192:193], v228 offset:0
ds_read_b64_tr_b16 v[194:195], v228 offset:1024
s_add_u32 m0, s34, s71
s_add_u32 s3, s31, 16384
buffer_load_dwordx4 v238, s[20:23], s3 offen offset:0 lds
v_fma_f32 v48, v48, s62, -v249
v_fma_f32 v49, v49, s62, -v249
v_exp_f32 v48, v48
v_exp_f32 v49, v49
v_mfma_f32_32x32x16_bf16 v[112:127], v[196:199], v[132:135], v[112:127]
ds_read_b64_tr_b16 v[196:197], v229 offset:0
ds_read_b64_tr_b16 v[198:199], v229 offset:1024
v_fma_f32 v50, v50, s62, -v249
v_fma_f32 v51, v51, s62, -v249
v_exp_f32 v50, v50
v_exp_f32 v51, v51
s_waitcnt lgkmcnt(8)
v_mfma_f32_32x32x16_bf16 v[112:127], v[200:203], v[136:139], v[112:127]
ds_read_b64_tr_b16 v[200:201], v228 offset:4096
ds_read_b64_tr_b16 v[202:203], v228 offset:5120
v_xor_b32 v240, 64, v238
buffer_load_dwordx4 v240, s[20:23], s3 offen offset:1024 lds
v_add_f32 v250, v250, v48
v_add_f32 v250, v250, v49
v_cvt_pk_bf16_f32 v24, v48, v49
v_fma_f32 v52, v52, s62, -v249
v_fma_f32 v53, v53, s62, -v249
v_mfma_f32_32x32x16_bf16 v[112:127], v[204:207], v[140:143], v[112:127]
ds_read_b64_tr_b16 v[204:205], v229 offset:4096
ds_read_b64_tr_b16 v[206:207], v229 offset:5120
v_exp_f32 v52, v52
v_exp_f32 v53, v53
v_add_f32 v250, v250, v50
s_waitcnt lgkmcnt(10)
v_mfma_f32_32x32x16_bf16 v[112:127], v[208:211], v[144:147], v[112:127]
ds_read_b64_tr_b16 v[208:209], v228 offset:8192
ds_read_b64_tr_b16 v[210:211], v228 offset:9216
v_xor_b32 v240, 128, v238
buffer_load_dwordx4 v240, s[20:23], s3 offen offset:2048 lds
v_add_f32 v250, v250, v51
v_cvt_pk_bf16_f32 v25, v50, v51
v_fma_f32 v54, v54, s62, -v249
v_fma_f32 v55, v55, s62, -v249
v_exp_f32 v54, v54
v_mfma_f32_32x32x16_bf16 v[112:127], v[212:215], v[148:151], v[112:127]
ds_read_b64_tr_b16 v[212:213], v229 offset:8192
ds_read_b64_tr_b16 v[214:215], v229 offset:9216
v_exp_f32 v55, v55
v_add_f32 v250, v250, v52
v_add_f32 v250, v250, v53
v_cvt_pk_bf16_f32 v26, v52, v53
s_waitcnt lgkmcnt(12)
v_mfma_f32_32x32x16_bf16 v[112:127], v[216:219], v[152:155], v[112:127]
ds_read_b64_tr_b16 v[216:217], v228 offset:12288
ds_read_b64_tr_b16 v[218:219], v228 offset:13312
v_xor_b32 v240, 192, v238
buffer_load_dwordx4 v240, s[20:23], s3 offen offset:3072 lds
v_fma_f32 v56, v56, s62, -v249
v_fma_f32 v57, v57, s62, -v249
v_exp_f32 v56, v56
v_exp_f32 v57, v57
v_mfma_f32_32x32x16_bf16 v[112:127], v[220:223], v[156:159], v[112:127]
ds_read_b64_tr_b16 v[220:221], v229 offset:12288
ds_read_b64_tr_b16 v[222:223], v229 offset:13312
s_mov_b32 s35, s60
s_add_u32 s60, s60, 16384
s_cmp_ge_u32 s60, 81920
s_cselect_b32 s60, 0, s60
v_add_u32 v224, s60, v233
v_xor_b32 v225, 64, v224
v_xor_b32 v226, 128, v224
v_xor_b32 v227, 192, v224
s_mov_b32 s34, s61
s_add_u32 s61, s61, 16384
s_cmp_ge_u32 s61, 131072
s_cselect_b32 s61, 81920, s61
v_add_u32 v228, s61, v235
v_xor_b32 v229, 64, v228
v_xor_b32 v230, 128, v228
v_xor_b32 v231, 192, v228
v_add_f32 v250, v250, v54
v_add_f32 v250, v250, v55
v_cvt_pk_bf16_f32 v27, v54, v55
v_fma_f32 v58, v58, s62, -v249
v_fma_f32 v59, v59, s62, -v249
s_waitcnt lgkmcnt(12)
v_mfma_f32_32x32x16_bf16 v[160:175], v[192:195], a[240:243], v[160:175]
ds_read_b64_tr_b16 v[192:193], v224 offset:0
ds_read_b64_tr_b16 v[194:195], v224 offset:2048
s_add_u32 m0, s33, s71
s_add_u32 s7, s30, 49152
buffer_load_dwordx4 v237, s[12:15], s7 offen offset:0 nt lds
v_exp_f32 v58, v58
v_exp_f32 v59, v59
v_add_f32 v250, v250, v56
v_mfma_f32_32x32x16_bf16 v[176:191], v[196:199], a[240:243], v[176:191]
ds_read_b64_tr_b16 v[196:197], v225 offset:0
ds_read_b64_tr_b16 v[198:199], v225 offset:2048
v_add_f32 v250, v250, v57
v_cvt_pk_bf16_f32 v28, v56, v57
v_fma_f32 v60, v60, s62, -v249
v_fma_f32 v61, v61, s62, -v249
v_exp_f32 v60, v60
s_waitcnt lgkmcnt(12)
v_mfma_f32_32x32x16_bf16 v[160:175], v[200:203], a[244:247], v[160:175]
ds_read_b64_tr_b16 v[200:201], v224 offset:4096
ds_read_b64_tr_b16 v[202:203], v224 offset:6144
buffer_load_dwordx4 v237, s[12:15], s7 offen offset:1024 nt lds
v_exp_f32 v61, v61
v_add_f32 v250, v250, v58
v_add_f32 v250, v250, v59
v_cvt_pk_bf16_f32 v29, v58, v59
v_mfma_f32_32x32x16_bf16 v[176:191], v[204:207], a[244:247], v[176:191]
ds_read_b64_tr_b16 v[204:205], v225 offset:4096
ds_read_b64_tr_b16 v[206:207], v225 offset:6144
v_fma_f32 v62, v62, s62, -v249
v_fma_f32 v63, v63, s62, -v249
v_exp_f32 v62, v62
v_exp_f32 v63, v63
s_waitcnt lgkmcnt(12)
v_mfma_f32_32x32x16_bf16 v[160:175], v[208:211], a[248:251], v[160:175]
ds_read_b64_tr_b16 v[208:209], v226 offset:0
ds_read_b64_tr_b16 v[210:211], v226 offset:2048
buffer_load_dwordx4 v237, s[12:15], s7 offen offset:2048 nt lds
v_add_f32 v250, v250, v60
v_add_f32 v250, v250, v61
v_cvt_pk_bf16_f32 v30, v60, v61
s_nop 0
v_mfma_f32_32x32x16_bf16 v[176:191], v[212:215], a[248:251], v[176:191]
ds_read_b64_tr_b16 v[212:213], v227 offset:0
ds_read_b64_tr_b16 v[214:215], v227 offset:2048
v_add_f32 v250, v250, v62
v_add_f32 v250, v250, v63
v_cvt_pk_bf16_f32 v31, v62, v63
v_max3_f32 v248, v248, v96, v97
s_waitcnt lgkmcnt(12)
v_mfma_f32_32x32x16_bf16 v[160:175], v[216:219], a[252:255], v[160:175]
ds_read_b64_tr_b16 v[216:217], v226 offset:4096
ds_read_b64_tr_b16 v[218:219], v226 offset:6144
buffer_load_dwordx4 v237, s[12:15], s7 offen offset:3072 nt lds
s_mov_b32 s33, s35
v_max3_f32 v248, v248, v98, v99
v_max3_f32 v248, v248, v100, v101
v_max3_f32 v248, v248, v102, v103
v_max3_f32 v248, v248, v104, v105
v_mfma_f32_32x32x16_bf16 v[176:191], v[220:223], a[252:255], v[176:191]
ds_read_b64_tr_b16 v[220:221], v227 offset:4096
ds_read_b64_tr_b16 v[222:223], v227 offset:6144
v_max3_f32 v248, v248, v106, v107
v_max3_f32 v248, v248, v108, v109
v_max3_f32 v248, v248, v110, v111
s_cmp_lg_u32 s29, 7
s_cbranch_scc1 L_nosw
s_mov_b32 s8, s46
s_mov_b32 s9, s47
s_mov_b32 s10, 0x120000
v_mov_b32 v236, v238
L_nosw:
s_waitcnt vmcnt(12)
s_barrier
ds_read_b128 v[244:247], v242 offset:0
s_waitcnt lgkmcnt(13)
v_mfma_f32_32x32x16_bf16 v[32:47], v[192:195], v[0:3], 0
ds_read_b64_tr_b16 v[192:193], v228 offset:0
ds_read_b64_tr_b16 v[194:195], v228 offset:4096
v_cvt_pk_bf16_f32 v128, v160, v161
v_cvt_pk_bf16_f32 v129, v162, v163
v_cvt_pk_bf16_f32 v130, v164, v165
v_cvt_pk_bf16_f32 v131, v166, v167
s_add_u32 m0, s34, s71
s_add_u32 s3, s31, 32768
buffer_load_dwordx4 v238, s[20:23], s3 offen offset:0 lds
v_mfma_f32_32x32x16_bf16 v[48:63], v[196:199], v[0:3], 0
ds_read_b64_tr_b16 v[196:197], v229 offset:0
ds_read_b64_tr_b16 v[198:199], v229 offset:4096
v_cvt_pk_bf16_f32 v132, v168, v169
v_cvt_pk_bf16_f32 v133, v170, v171
v_cvt_pk_bf16_f32 v134, v172, v173
v_cvt_pk_bf16_f32 v135, v174, v175
s_waitcnt lgkmcnt(13)
v_mfma_f32_32x32x16_bf16 v[32:47], v[200:203], v[4:7], v[32:47]
ds_read_b64_tr_b16 v[200:201], v230 offset:0
ds_read_b64_tr_b16 v[202:203], v230 offset:4096
v_cvt_pk_bf16_f32 v136, v176, v177
v_cvt_pk_bf16_f32 v137, v178, v179
v_cvt_pk_bf16_f32 v138, v180, v181
v_cvt_pk_bf16_f32 v139, v182, v183
v_xor_b32 v240, 64, v238
buffer_load_dwordx4 v240, s[20:23], s3 offen offset:1024 lds
v_mfma_f32_32x32x16_bf16 v[48:63], v[204:207], v[4:7], v[48:63]
ds_read_b64_tr_b16 v[204:205], v231 offset:0
ds_read_b64_tr_b16 v[206:207], v231 offset:4096
v_cvt_pk_bf16_f32 v140, v184, v185
v_cvt_pk_bf16_f32 v141, v186, v187
v_cvt_pk_bf16_f32 v142, v188, v189
v_cvt_pk_bf16_f32 v143, v190, v191
s_waitcnt lgkmcnt(13)
v_mfma_f32_32x32x16_bf16 v[160:175], v[208:211], v[0:3], 0
ds_read_b64_tr_b16 v[208:209], v228 offset:256
ds_read_b64_tr_b16 v[210:211], v228 offset:4352
ds_write_b128 v241, v[128:131] offset:4096
ds_write_b128 v241, v[132:135] offset:5120
ds_write_b128 v241, v[136:139] offset:6144
ds_write_b128 v241, v[140:143] offset:7168
v_xor_b32 v240, 128, v238
buffer_load_dwordx4 v240, s[20:23], s3 offen offset:2048 lds
v_mfma_f32_32x32x16_bf16 v[176:191], v[212:215], v[0:3], 0
ds_read_b64_tr_b16 v[212:213], v229 offset:256
ds_read_b64_tr_b16 v[214:215], v229 offset:4352
v_max3_f32 v248, v248, v112, v113
v_max3_f32 v248, v248, v114, v115
s_waitcnt lgkmcnt(15)
v_mfma_f32_32x32x16_bf16 v[160:175], v[216:219], v[4:7], v[160:175]
ds_read_b64_tr_b16 v[216:217], v230 offset:256
ds_read_b64_tr_b16 v[218:219], v230 offset:4352
v_xor_b32 v240, 192, v238
buffer_load_dwordx4 v240, s[20:23], s3 offen offset:3072 lds
v_max3_f32 v248, v248, v116, v117
v_max3_f32 v248, v248, v118, v119
v_mfma_f32_32x32x16_bf16 v[176:191], v[220:223], v[4:7], v[176:191]
ds_read_b64_tr_b16 v[220:221], v231 offset:256
ds_read_b64_tr_b16 v[222:223], v231 offset:4352
s_mov_b32 s35, s60
s_add_u32 s60, s60, 16384
s_cmp_ge_u32 s60, 81920
s_cselect_b32 s60, 0, s60
v_add_u32 v224, s60, v233
v_xor_b32 v225, 64, v224
v_xor_b32 v226, 128, v224
v_xor_b32 v227, 192, v224
s_mov_b32 s34, s61
s_add_u32 s61, s61, 16384
s_cmp_ge_u32 s61, 131072
s_cselect_b32 s61, 81920, s61
v_add_u32 v228, s61, v235
v_xor_b32 v229, 64, v228
v_xor_b32 v230, 128, v228
v_xor_b32 v231, 192, v228
v_max3_f32 v248, v248, v120, v121
v_max3_f32 v248, v248, v122, v123
s_waitcnt lgkmcnt(15)
v_mfma_f32_32x32x16_bf16 a[0:15], v[192:195], v[244:247], a[0:15]
ds_read_b64_tr_b16 v[192:193], v224 offset:0
ds_read_b64_tr_b16 v[194:195], v224 offset:2048
s_add_u32 m0, s33, s71
s_add_u32 s7, s30, 65536
buffer_load_dwordx4 v237, s[12:15], s7 offen offset:0 nt lds
v_max3_f32 v248, v248, v124, v125
v_max3_f32 v248, v248, v126, v127
v_mfma_f32_32x32x16_bf16 a[16:31], v[196:199], v[244:247], a[16:31]
ds_read_b64_tr_b16 v[196:197], v225 offset:0
ds_read_b64_tr_b16 v[198:199], v225 offset:2048
v_mov_b32 v251, v248
s_nop 1
s_waitcnt lgkmcnt(15)
v_mfma_f32_32x32x16_bf16 a[32:47], v[200:203], v[244:247], a[32:47]
ds_read_b64_tr_b16 v[200:201], v224 offset:4096
ds_read_b64_tr_b16 v[202:203], v224 offset:6144
buffer_load_dwordx4 v237, s[12:15], s7 offen offset:1024 nt lds
v_permlane32_swap_b32 v248, v251
v_max_f32 v248, v248, v251
v_mfma_f32_32x32x16_bf16 a[48:63], v[204:207], v[244:247], a[48:63]
ds_read_b64_tr_b16 v[204:205], v225 offset:4096
ds_read_b64_tr_b16 v[206:207], v225 offset:6144
v_mul_f32 v254, s62, v248
v_sub_f32 v251, v249, v254
s_waitcnt lgkmcnt(12)
v_mfma_f32_32x32x16_bf16 a[64:79], v[208:211], v[244:247], a[64:79]
ds_read_b64_tr_b16 v[208:209], v226 offset:0
ds_read_b64_tr_b16 v[210:211], v226 offset:2048
buffer_load_dwordx4 v237, s[12:15], s7 offen offset:2048 nt lds
v_exp_f32 v251, v251
v_mfma_f32_32x32x16_bf16 a[80:95], v[212:215], v[244:247], a[80:95]
ds_read_b64_tr_b16 v[212:213], v227 offset:0
ds_read_b64_tr_b16 v[214:215], v227 offset:2048
v_mov_b32 v249, v254
s_waitcnt lgkmcnt(12)
v_mfma_f32_32x32x16_bf16 a[96:111], v[216:219], v[244:247], a[96:111]
ds_read_b64_tr_b16 v[216:217], v226 offset:4096
ds_read_b64_tr_b16 v[218:219], v226 offset:6144
buffer_load_dwordx4 v237, s[12:15], s7 offen offset:3072 nt lds
s_mov_b32 s33, s35
v_mul_f32 v250, v250, v251
v_mfma_f32_32x32x16_bf16 a[112:127], v[220:223], v[244:247], a[112:127]
ds_read_b64_tr_b16 v[220:221], v227 offset:4096
ds_read_b64_tr_b16 v[222:223], v227 offset:6144
s_waitcnt vmcnt(12)
s_barrier
ds_read_b128 v[244:247], v242 offset:1024
ds_read_b128 v[128:131], v242 offset:4096
ds_read_b128 v[132:135], v242 offset:5120
ds_read_b128 v[136:139], v242 offset:6144
ds_read_b128 v[140:143], v242 offset:7168
ds_read_b128 v[144:147], v242 offset:20480
ds_read_b128 v[148:151], v242 offset:21504
ds_read_b128 v[152:155], v242 offset:22528
ds_read_b128 v[156:159], v242 offset:23552
s_waitcnt lgkmcnt(15)
v_mfma_f32_32x32x16_bf16 v[32:47], v[192:195], v[8:11], v[32:47]
ds_read_b64_tr_b16 v[192:193], v228 offset:0
ds_read_b64_tr_b16 v[194:195], v228 offset:4096
s_add_u32 m0, s34, s71
s_add_u32 s3, s31, 49152
buffer_load_dwordx4 v238, s[20:23], s3 offen offset:0 lds
v_fma_f32 v64, v64, s62, -v249
v_fma_f32 v65, v65, s62, -v249
v_exp_f32 v64, v64
v_exp_f32 v65, v65
v_mfma_f32_32x32x16_bf16 v[48:63], v[196:199], v[8:11], v[48:63]
ds_read_b64_tr_b16 v[196:197], v229 offset:0
ds_read_b64_tr_b16 v[198:199], v229 offset:4096
v_fma_f32 v66, v66, s62, -v249
v_fma_f32 v67, v67, s62, -v249
v_exp_f32 v66, v66
v_exp_f32 v67, v67
s_waitcnt lgkmcnt(15)
v_mfma_f32_32x32x16_bf16 v[32:47], v[200:203], v[12:15], v[32:47]
ds_read_b64_tr_b16 v[200:201], v230 offset:0
ds_read_b64_tr_b16 v[202:203], v230 offset:4096
v_xor_b32 v240, 64, v238
buffer_load_dwordx4 v240, s[20:23], s3 offen offset:1024 lds
v_add_f32 v250, v250, v64
v_add_f32 v250, v250, v65
v_cvt_pk_bf16_f32 v64, v64, v65
v_fma_f32 v68, v68, s62, -v249
v_fma_f32 v69, v69, s62, -v249
v_mfma_f32_32x32x16_bf16 v[48:63], v[204:207], v[12:15], v[48:63]
ds_read_b64_tr_b16 v[204:205], v231 offset:0
ds_read_b64_tr_b16 v[206:207], v231 offset:4096
v_exp_f32 v68, v68
v_exp_f32 v69, v69
v_add_f32 v250, v250, v66
s_waitcnt lgkmcnt(15)
v_mfma_f32_32x32x16_bf16 v[160:175], v[208:211], v[8:11], v[160:175]
ds_read_b64_tr_b16 v[208:209], v228 offset:256
ds_read_b64_tr_b16 v[210:211], v228 offset:4352
v_xor_b32 v240, 128, v238
buffer_load_dwordx4 v240, s[20:23], s3 offen offset:2048 lds
v_add_f32 v250, v250, v67
v_cvt_pk_bf16_f32 v65, v66, v67
v_fma_f32 v70, v70, s62, -v249
v_fma_f32 v71, v71, s62, -v249
v_exp_f32 v70, v70
v_mfma_f32_32x32x16_bf16 v[176:191], v[212:215], v[8:11], v[176:191]
ds_read_b64_tr_b16 v[212:213], v229 offset:256
ds_read_b64_tr_b16 v[214:215], v229 offset:4352
v_exp_f32 v71, v71
v_add_f32 v250, v250, v68
v_add_f32 v250, v250, v69
v_cvt_pk_bf16_f32 v66, v68, v69
s_waitcnt lgkmcnt(15)
v_mfma_f32_32x32x16_bf16 v[160:175], v[216:219], v[12:15], v[160:175]
ds_read_b64_tr_b16 v[216:217], v230 offset:256
ds_read_b64_tr_b16 v[218:219], v230 offset:4352
v_xor_b32 v240, 192, v238
buffer_load_dwordx4 v240, s[20:23], s3 offen offset:3072 lds
v_fma_f32 v72, v72, s62, -v249
v_fma_f32 v73, v73, s62, -v249
v_exp_f32 v72, v72
v_mfma_f32_32x32x16_bf16 v[176:191], v[220:223], v[12:15], v[176:191]
ds_read_b64_tr_b16 v[220:221], v231 offset:256
ds_read_b64_tr_b16 v[222:223], v231 offset:4352
s_mov_b32 s35, s60
s_add_u32 s60, s60, 16384
s_cmp_ge_u32 s60, 81920
s_cselect_b32 s60, 0, s60
v_add_u32 v224, s60, v233
v_xor_b32 v225, 64, v224
v_xor_b32 v226, 128, v224
v_xor_b32 v227, 192, v224
s_mov_b32 s34, s61
s_add_u32 s61, s61, 16384
s_cmp_ge_u32 s61, 131072
s_cselect_b32 s61, 81920, s61
v_add_u32 v228, s61, v235
v_xor_b32 v229, 64, v228
v_xor_b32 v230, 128, v228
v_xor_b32 v231, 192, v228
v_exp_f32 v73, v73
v_add_f32 v250, v250, v70
v_add_f32 v250, v250, v71
s_waitcnt lgkmcnt(12)
v_mfma_f32_32x32x16_bf16 a[0:15], v[192:195], v[244:247], a[0:15]
ds_read_b64_tr_b16 v[192:193], v224 offset:0
ds_read_b64_tr_b16 v[194:195], v224 offset:2048
s_add_u32 m0, s33, s71
s_add_u32 s7, s30, 81920
buffer_load_dwordx4 v237, s[12:15], s7 offen offset:0 nt lds
v_cvt_pk_bf16_f32 v67, v70, v71
v_fma_f32 v74, v74, s62, -v249
v_fma_f32 v75, v75, s62, -v249
v_exp_f32 v74, v74
v_mfma_f32_32x32x16_bf16 a[16:31], v[196:199], v[244:247], a[16:31]
ds_read_b64_tr_b16 v[196:197], v225 offset:0
ds_read_b64_tr_b16 v[198:199], v225 offset:2048
v_exp_f32 v75, v75
v_add_f32 v250, v250, v72
v_add_f32 v250, v250, v73
s_waitcnt lgkmcnt(12)
v_mfma_f32_32x32x16_bf16 a[32:47], v[200:203], v[244:247], a[32:47]
ds_read_b64_tr_b16 v[200:201], v224 offset:4096
ds_read_b64_tr_b16 v[202:203], v224 offset:6144
buffer_load_dwordx4 v237, s[12:15], s7 offen offset:1024 nt lds
v_cvt_pk_bf16_f32 v68, v72, v73
v_fma_f32 v76, v76, s62, -v249
v_fma_f32 v77, v77, s62, -v249
v_exp_f32 v76, v76
v_mfma_f32_32x32x16_bf16 a[48:63], v[204:207], v[244:247], a[48:63]
ds_read_b64_tr_b16 v[204:205], v225 offset:4096
ds_read_b64_tr_b16 v[206:207], v225 offset:6144
v_exp_f32 v77, v77
v_add_f32 v250, v250, v74
v_add_f32 v250, v250, v75
s_waitcnt lgkmcnt(12)
v_mfma_f32_32x32x16_bf16 a[64:79], v[208:211], v[244:247], a[64:79]
ds_read_b64_tr_b16 v[208:209], v226 offset:0
ds_read_b64_tr_b16 v[210:211], v226 offset:2048
buffer_load_dwordx4 v237, s[12:15], s7 offen offset:2048 nt lds
v_cvt_pk_bf16_f32 v69, v74, v75
v_fma_f32 v78, v78, s62, -v249
v_fma_f32 v79, v79, s62, -v249
v_exp_f32 v78, v78
v_mfma_f32_32x32x16_bf16 a[80:95], v[212:215], v[244:247], a[80:95]
ds_read_b64_tr_b16 v[212:213], v227 offset:0
ds_read_b64_tr_b16 v[214:215], v227 offset:2048
v_exp_f32 v79, v79
v_add_f32 v250, v250, v76
s_waitcnt lgkmcnt(12)
v_mfma_f32_32x32x16_bf16 a[96:111], v[216:219], v[244:247], a[96:111]
ds_read_b64_tr_b16 v[216:217], v226 offset:4096
ds_read_b64_tr_b16 v[218:219], v226 offset:6144
buffer_load_dwordx4 v237, s[12:15], s7 offen offset:3072 nt lds
s_mov_b32 s33, s35
v_add_f32 v250, v250, v77
v_cvt_pk_bf16_f32 v70, v76, v77
s_nop 0
v_mfma_f32_32x32x16_bf16 a[112:127], v[220:223], v[244:247], a[112:127]
ds_read_b64_tr_b16 v[220:221], v227 offset:4096
ds_read_b64_tr_b16 v[222:223], v227 offset:6144
v_add_f32 v250, v250, v78
v_add_f32 v250, v250, v79
v_cvt_pk_bf16_f32 v71, v78, v79
s_waitcnt vmcnt(12)
s_barrier
ds_read_b128 v[244:247], v242 offset:2048
s_waitcnt lgkmcnt(13)
v_mfma_f32_32x32x16_bf16 v[32:47], v[192:195], v[16:19], v[32:47]
ds_read_b64_tr_b16 v[192:193], v228 offset:0
ds_read_b64_tr_b16 v[194:195], v228 offset:4096
s_add_u32 m0, s34, s71
s_add_u32 s3, s31, 65536
buffer_load_dwordx4 v238, s[20:23], s3 offen offset:0 lds
v_fma_f32 v80, v80, s62, -v249
v_fma_f32 v81, v81, s62, -v249
v_exp_f32 v80, v80
v_exp_f32 v81, v81
v_mfma_f32_32x32x16_bf16 v[48:63], v[196:199], v[16:19], v[48:63]
ds_read_b64_tr_b16 v[196:197], v229 offset:0
ds_read_b64_tr_b16 v[198:199], v229 offset:4096
v_fma_f32 v82, v82, s62, -v249
v_fma_f32 v83, v83, s62, -v249
v_exp_f32 v82, v82
v_exp_f32 v83, v83
s_waitcnt lgkmcnt(13)
v_mfma_f32_32x32x16_bf16 v[32:47], v[200:203], v[20:23], v[32:47]
ds_read_b64_tr_b16 v[200:201], v230 offset:0
ds_read_b64_tr_b16 v[202:203], v230 offset:4096
v_xor_b32 v240, 64, v238
buffer_load_dwordx4 v240, s[20:23], s3 offen offset:1024 lds
v_add_f32 v250, v250, v80
v_add_f32 v250, v250, v81
v_cvt_pk_bf16_f32 v72, v80, v81
v_fma_f32 v84, v84, s62, -v249
v_fma_f32 v85, v85, s62, -v249
v_mfma_f32_32x32x16_bf16 v[48:63], v[204:207], v[20:23], v[48:63]
ds_read_b64_tr_b16 v[204:205], v231 offset:0
ds_read_b64_tr_b16 v[206:207], v231 offset:4096
v_exp_f32 v84, v84
v_exp_f32 v85, v85
v_add_f32 v250, v250, v82
s_waitcnt lgkmcnt(13)
v_mfma_f32_32x32x16_bf16 v[160:175], v[208:211], v[16:19], v[160:175]
ds_read_b64_tr_b16 v[208:209], v228 offset:256
ds_read_b64_tr_b16 v[210:211], v228 offset:4352
v_xor_b32 v240, 128, v238
buffer_load_dwordx4 v240, s[20:23], s3 offen offset:2048 lds
v_add_f32 v250, v250, v83
v_cvt_pk_bf16_f32 v73, v82, v83
v_fma_f32 v86, v86, s62, -v249
v_fma_f32 v87, v87, s62, -v249
v_exp_f32 v86, v86
v_mfma_f32_32x32x16_bf16 v[176:191], v[212:215], v[16:19], v[176:191]
ds_read_b64_tr_b16 v[212:213], v229 offset:256
ds_read_b64_tr_b16 v[214:215], v229 offset:4352
v_exp_f32 v87, v87
v_add_f32 v250, v250, v84
v_add_f32 v250, v250, v85
v_cvt_pk_bf16_f32 v74, v84, v85
s_waitcnt lgkmcnt(13)
v_mfma_f32_32x32x16_bf16 v[160:175], v[216:219], v[20:23], v[160:175]
ds_read_b64_tr_b16 v[216:217], v230 offset:256
ds_read_b64_tr_b16 v[218:219], v230 offset:4352
v_xor_b32 v240, 192, v238
buffer_load_dwordx4 v240, s[20:23], s3 offen offset:3072 lds
v_fma_f32 v88, v88, s62, -v249
v_fma_f32 v89, v89, s62, -v249
v_exp_f32 v88, v88
v_mfma_f32_32x32x16_bf16 v[176:191], v[220:223], v[20:23], v[176:191]
ds_read_b64_tr_b16 v[220:221], v231 offset:256
ds_read_b64_tr_b16 v[222:223], v231 offset:4352
s_mov_b32 s35, s60
s_add_u32 s60, s60, 16384
s_cmp_ge_u32 s60, 81920
s_cselect_b32 s60, 0, s60
v_add_u32 v224, s60, v233
v_xor_b32 v225, 64, v224
v_xor_b32 v226, 128, v224
v_xor_b32 v227, 192, v224
s_mov_b32 s34, s61
s_add_u32 s61, s61, 16384
s_cmp_ge_u32 s61, 131072
s_cselect_b32 s61, 81920, s61
v_add_u32 v228, s61, v235
v_xor_b32 v229, 64, v228
v_xor_b32 v230, 128, v228
v_xor_b32 v231, 192, v228
v_exp_f32 v89, v89
v_add_f32 v250, v250, v86
v_add_f32 v250, v250, v87
s_waitcnt lgkmcnt(12)
v_mfma_f32_32x32x16_bf16 a[0:15], v[192:195], v[244:247], a[0:15]
ds_read_b64_tr_b16 v[192:193], v224 offset:0
ds_read_b64_tr_b16 v[194:195], v224 offset:2048
s_add_u32 m0, s33, s71
s_add_u32 s7, s30, 98304
buffer_load_dwordx4 v237, s[12:15], s7 offen offset:0 nt lds
v_cvt_pk_bf16_f32 v75, v86, v87
v_fma_f32 v90, v90, s62, -v249
v_fma_f32 v91, v91, s62, -v249
v_exp_f32 v90, v90
v_mfma_f32_32x32x16_bf16 a[16:31], v[196:199], v[244:247], a[16:31]
ds_read_b64_tr_b16 v[196:197], v225 offset:0
ds_read_b64_tr_b16 v[198:199], v225 offset:2048
v_exp_f32 v91, v91
v_add_f32 v250, v250, v88
v_add_f32 v250, v250, v89
s_waitcnt lgkmcnt(12)
v_mfma_f32_32x32x16_bf16 a[32:47], v[200:203], v[244:247], a[32:47]
ds_read_b64_tr_b16 v[200:201], v224 offset:4096
ds_read_b64_tr_b16 v[202:203], v224 offset:6144
buffer_load_dwordx4 v237, s[12:15], s7 offen offset:1024 nt lds
v_cvt_pk_bf16_f32 v76, v88, v89
v_fma_f32 v92, v92, s62, -v249
v_fma_f32 v93, v93, s62, -v249
v_exp_f32 v92, v92
v_mfma_f32_32x32x16_bf16 a[48:63], v[204:207], v[244:247], a[48:63]
ds_read_b64_tr_b16 v[204:205], v225 offset:4096
ds_read_b64_tr_b16 v[206:207], v225 offset:6144
v_exp_f32 v93, v93
v_add_f32 v250, v250, v90
v_add_f32 v250, v250, v91
s_waitcnt lgkmcnt(12)
v_mfma_f32_32x32x16_bf16 a[64:79], v[208:211], v[244:247], a[64:79]
ds_read_b64_tr_b16 v[208:209], v226 offset:0
ds_read_b64_tr_b16 v[210:211], v226 offset:2048
buffer_load_dwordx4 v237, s[12:15], s7 offen offset:2048 nt lds
v_cvt_pk_bf16_f32 v77, v90, v91
v_fma_f32 v94, v94, s62, -v249
v_fma_f32 v95, v95, s62, -v249
v_exp_f32 v94, v94
v_mfma_f32_32x32x16_bf16 a[80:95], v[212:215], v[244:247], a[80:95]
ds_read_b64_tr_b16 v[212:213], v227 offset:0
ds_read_b64_tr_b16 v[214:215], v227 offset:2048
v_exp_f32 v95, v95
v_add_f32 v250, v250, v92
s_waitcnt lgkmcnt(12)
v_mfma_f32_32x32x16_bf16 a[96:111], v[216:219], v[244:247], a[96:111]
ds_read_b64_tr_b16 v[216:217], v226 offset:4096
ds_read_b64_tr_b16 v[218:219], v226 offset:6144
buffer_load_dwordx4 v237, s[12:15], s7 offen offset:3072 nt lds
s_mov_b32 s33, s35
v_add_f32 v250, v250, v93
v_cvt_pk_bf16_f32 v78, v92, v93
s_nop 0
v_mfma_f32_32x32x16_bf16 a[112:127], v[220:223], v[244:247], a[112:127]
ds_read_b64_tr_b16 v[220:221], v227 offset:4096
ds_read_b64_tr_b16 v[222:223], v227 offset:6144
v_add_f32 v250, v250, v94
v_add_f32 v250, v250, v95
v_cvt_pk_bf16_f32 v79, v94, v95
s_waitcnt vmcnt(12)
s_barrier
ds_read_b128 v[244:247], v242 offset:3072
s_waitcnt lgkmcnt(13)
v_mfma_f32_32x32x16_bf16 v[32:47], v[192:195], v[24:27], v[32:47]
ds_read_b64_tr_b16 v[192:193], v228 offset:0
ds_read_b64_tr_b16 v[194:195], v228 offset:4096
s_add_u32 m0, s34, s71
s_add_u32 s3, s31, 81920
buffer_load_dwordx4 v238, s[20:23], s3 offen offset:0 lds
v_mfma_f32_32x32x16_bf16 v[48:63], v[196:199], v[24:27], v[48:63]
ds_read_b64_tr_b16 v[196:197], v229 offset:0
ds_read_b64_tr_b16 v[198:199], v229 offset:4096
s_waitcnt lgkmcnt(13)
v_mfma_f32_32x32x16_bf16 v[32:47], v[200:203], v[28:31], v[32:47]
ds_read_b64_tr_b16 v[200:201], v230 offset:0
ds_read_b64_tr_b16 v[202:203], v230 offset:4096
v_xor_b32 v240, 64, v238
buffer_load_dwordx4 v240, s[20:23], s3 offen offset:1024 lds
v_mfma_f32_32x32x16_bf16 v[48:63], v[204:207], v[28:31], v[48:63]
ds_read_b64_tr_b16 v[204:205], v231 offset:0
ds_read_b64_tr_b16 v[206:207], v231 offset:4096
s_waitcnt lgkmcnt(13)
v_mfma_f32_32x32x16_bf16 v[160:175], v[208:211], v[24:27], v[160:175]
ds_read_b64_tr_b16 v[208:209], v228 offset:256
ds_read_b64_tr_b16 v[210:211], v228 offset:4352
v_xor_b32 v240, 128, v238
buffer_load_dwordx4 v240, s[20:23], s3 offen offset:2048 lds
v_mfma_f32_32x32x16_bf16 v[176:191], v[212:215], v[24:27], v[176:191]
ds_read_b64_tr_b16 v[212:213], v229 offset:256
ds_read_b64_tr_b16 v[214:215], v229 offset:4352
v_mul_f32 v32, v32, v251
v_mul_f32 v33, v33, v251
v_mul_f32 v34, v34, v251
v_mul_f32 v35, v35, v251
v_mul_f32 v36, v36, v251
v_mul_f32 v37, v37, v251
s_waitcnt lgkmcnt(13)
v_mfma_f32_32x32x16_bf16 v[160:175], v[216:219], v[28:31], v[160:175]
ds_read_b64_tr_b16 v[216:217], v230 offset:256
ds_read_b64_tr_b16 v[218:219], v230 offset:4352
v_xor_b32 v240, 192, v238
buffer_load_dwordx4 v240, s[20:23], s3 offen offset:3072 lds
v_mul_f32 v38, v38, v251
v_mul_f32 v39, v39, v251
v_mul_f32 v40, v40, v251
v_mul_f32 v41, v41, v251
v_mul_f32 v42, v42, v251
v_mul_f32 v43, v43, v251
v_mfma_f32_32x32x16_bf16 v[176:191], v[220:223], v[28:31], v[176:191]
ds_read_b64_tr_b16 v[220:221], v231 offset:256
ds_read_b64_tr_b16 v[222:223], v231 offset:4352
s_mov_b32 s35, s60
s_add_u32 s60, s60, 16384
s_cmp_ge_u32 s60, 81920
s_cselect_b32 s60, 0, s60
v_add_u32 v224, s60, v233
v_xor_b32 v225, 64, v224
v_xor_b32 v226, 128, v224
v_xor_b32 v227, 192, v224
s_mov_b32 s34, s61
s_add_u32 s61, s61, 16384
s_cmp_ge_u32 s61, 131072
s_cselect_b32 s61, 81920, s61
v_add_u32 v228, s61, v235
v_xor_b32 v229, 64, v228
v_xor_b32 v230, 128, v228
v_xor_b32 v231, 192, v228
v_mul_f32 v44, v44, v251
v_mul_f32 v45, v45, v251
v_mul_f32 v46, v46, v251
v_mul_f32 v47, v47, v251
v_mul_f32 v48, v48, v251
v_mul_f32 v49, v49, v251
s_waitcnt lgkmcnt(12)
v_mfma_f32_32x32x16_bf16 a[0:15], v[192:195], v[244:247], a[0:15]
ds_read_b64_tr_b16 v[192:193], v224 offset:0
ds_read_b64_tr_b16 v[194:195], v224 offset:2048
s_add_u32 m0, s33, s71
s_add_u32 s7, s30, 114688
buffer_load_dwordx4 v237, s[12:15], s7 offen offset:0 nt lds
v_mul_f32 v50, v50, v251
v_mul_f32 v51, v51, v251
v_mul_f32 v52, v52, v251
v_mul_f32 v53, v53, v251
v_mul_f32 v54, v54, v251
v_mul_f32 v55, v55, v251
v_mfma_f32_32x32x16_bf16 a[16:31], v[196:199], v[244:247], a[16:31]
ds_read_b64_tr_b16 v[196:197], v225 offset:0
ds_read_b64_tr_b16 v[198:199], v225 offset:2048
v_mul_f32 v56, v56, v251
v_mul_f32 v57, v57, v251
v_mul_f32 v58, v58, v251
v_mul_f32 v59, v59, v251
v_mul_f32 v60, v60, v251
v_mul_f32 v61, v61, v251
s_waitcnt lgkmcnt(12)
v_mfma_f32_32x32x16_bf16 a[32:47], v[200:203], v[244:247], a[32:47]
ds_read_b64_tr_b16 v[200:201], v224 offset:4096
ds_read_b64_tr_b16 v[202:203], v224 offset:6144
buffer_load_dwordx4 v237, s[12:15], s7 offen offset:1024 nt lds
v_mul_f32 v62, v62, v251
v_mul_f32 v63, v63, v251
v_mul_f32 v160, v160, v251
v_mul_f32 v161, v161, v251
v_mul_f32 v162, v162, v251
v_mul_f32 v163, v163, v251
v_mfma_f32_32x32x16_bf16 a[48:63], v[204:207], v[244:247], a[48:63]
ds_read_b64_tr_b16 v[204:205], v225 offset:4096
ds_read_b64_tr_b16 v[206:207], v225 offset:6144
v_mul_f32 v164, v164, v251
v_mul_f32 v165, v165, v251
v_mul_f32 v166, v166, v251
v_mul_f32 v167, v167, v251
v_mul_f32 v168, v168, v251
v_mul_f32 v169, v169, v251
s_waitcnt lgkmcnt(12)
v_mfma_f32_32x32x16_bf16 a[64:79], v[208:211], v[244:247], a[64:79]
ds_read_b64_tr_b16 v[208:209], v226 offset:0
ds_read_b64_tr_b16 v[210:211], v226 offset:2048
buffer_load_dwordx4 v237, s[12:15], s7 offen offset:2048 nt lds
v_mul_f32 v170, v170, v251
v_mul_f32 v171, v171, v251
v_mul_f32 v172, v172, v251
v_mul_f32 v173, v173, v251
v_mul_f32 v174, v174, v251
v_mul_f32 v175, v175, v251
v_mfma_f32_32x32x16_bf16 a[80:95], v[212:215], v[244:247], a[80:95]
ds_read_b64_tr_b16 v[212:213], v227 offset:0
ds_read_b64_tr_b16 v[214:215], v227 offset:2048
v_mul_f32 v176, v176, v251
v_mul_f32 v177, v177, v251
v_mul_f32 v178, v178, v251
v_mul_f32 v179, v179, v251
v_mul_f32 v180, v180, v251
v_mul_f32 v181, v181, v251
s_waitcnt lgkmcnt(12)
v_mfma_f32_32x32x16_bf16 a[96:111], v[216:219], v[244:247], a[96:111]
ds_read_b64_tr_b16 v[216:217], v226 offset:4096
ds_read_b64_tr_b16 v[218:219], v226 offset:6144
buffer_load_dwordx4 v237, s[12:15], s7 offen offset:3072 nt lds
s_mov_b32 s33, s35
v_mul_f32 v182, v182, v251
v_mul_f32 v183, v183, v251
v_mul_f32 v184, v184, v251
v_mul_f32 v185, v185, v251
v_mul_f32 v186, v186, v251
v_mfma_f32_32x32x16_bf16 a[112:127], v[220:223], v[244:247], a[112:127]
ds_read_b64_tr_b16 v[220:221], v227 offset:4096
ds_read_b64_tr_b16 v[222:223], v227 offset:6144
v_mul_f32 v187, v187, v251
v_mul_f32 v188, v188, v251
v_mul_f32 v189, v189, v251
v_mul_f32 v190, v190, v251
v_mul_f32 v191, v191, v251
s_waitcnt vmcnt(12)
s_barrier
ds_read_b128 v[244:247], v242 offset:16384
s_waitcnt lgkmcnt(13)
v_mfma_f32_32x32x16_bf16 v[32:47], v[192:195], v[64:67], v[32:47]
ds_read_b64_tr_b16 v[192:193], v228 offset:0
ds_read_b64_tr_b16 v[194:195], v228 offset:4096
s_add_u32 m0, s34, s71
s_add_u32 s3, s31, 98304
buffer_load_dwordx4 v238, s[20:23], s3 offen offset:0 lds
v_fma_f32 v96, v96, s62, -v249
v_fma_f32 v97, v97, s62, -v249
v_exp_f32 v96, v96
v_exp_f32 v97, v97
v_mfma_f32_32x32x16_bf16 v[48:63], v[196:199], v[64:67], v[48:63]
ds_read_b64_tr_b16 v[196:197], v229 offset:0
ds_read_b64_tr_b16 v[198:199], v229 offset:4096
v_fma_f32 v98, v98, s62, -v249
v_fma_f32 v99, v99, s62, -v249
v_exp_f32 v98, v98
v_exp_f32 v99, v99
s_waitcnt lgkmcnt(13)
v_mfma_f32_32x32x16_bf16 v[32:47], v[200:203], v[68:71], v[32:47]
ds_read_b64_tr_b16 v[200:201], v230 offset:0
ds_read_b64_tr_b16 v[202:203], v230 offset:4096
v_xor_b32 v240, 64, v238
buffer_load_dwordx4 v240, s[20:23], s3 offen offset:1024 lds
v_add_f32 v250, v250, v96
v_add_f32 v250, v250, v97
v_cvt_pk_bf16_f32 v80, v96, v97
v_fma_f32 v100, v100, s62, -v249
v_fma_f32 v101, v101, s62, -v249
v_mfma_f32_32x32x16_bf16 v[48:63], v[204:207], v[68:71], v[48:63]
ds_read_b64_tr_b16 v[204:205], v231 offset:0
ds_read_b64_tr_b16 v[206:207], v231 offset:4096
v_exp_f32 v100, v100
v_exp_f32 v101, v101
v_add_f32 v250, v250, v98
s_waitcnt lgkmcnt(13)
v_mfma_f32_32x32x16_bf16 v[160:175], v[208:211], v[64:67], v[160:175]
ds_read_b64_tr_b16 v[208:209], v228 offset:256
ds_read_b64_tr_b16 v[210:211], v228 offset:4352
v_xor_b32 v240, 128, v238
buffer_load_dwordx4 v240, s[20:23], s3 offen offset:2048 lds
v_add_f32 v250, v250, v99
v_cvt_pk_bf16_f32 v81, v98, v99
v_fma_f32 v102, v102, s62, -v249
v_fma_f32 v103, v103, s62, -v249
v_exp_f32 v102, v102
v_mfma_f32_32x32x16_bf16 v[176:191], v[212:215], v[64:67], v[176:191]
ds_read_b64_tr_b16 v[212:213], v229 offset:256
ds_read_b64_tr_b16 v[214:215], v229 offset:4352
v_exp_f32 v103, v103
v_add_f32 v250, v250, v100
v_add_f32 v250, v250, v101
v_cvt_pk_bf16_f32 v82, v100, v101
s_waitcnt lgkmcnt(13)
v_mfma_f32_32x32x16_bf16 v[160:175], v[216:219], v[68:71], v[160:175]
ds_read_b64_tr_b16 v[216:217], v230 offset:256
ds_read_b64_tr_b16 v[218:219], v230 offset:4352
v_xor_b32 v240, 192, v238
buffer_load_dwordx4 v240, s[20:23], s3 offen offset:3072 lds
v_fma_f32 v104, v104, s62, -v249
v_fma_f32 v105, v105, s62, -v249
v_exp_f32 v104, v104
v_mfma_f32_32x32x16_bf16 v[176:191], v[220:223], v[68:71], v[176:191]
ds_read_b64_tr_b16 v[220:221], v231 offset:256
ds_read_b64_tr_b16 v[222:223], v231 offset:4352
s_mov_b32 s35, s60
s_add_u32 s60, s60, 16384
s_cmp_ge_u32 s60, 81920
s_cselect_b32 s60, 0, s60
v_add_u32 v224, s60, v233
v_xor_b32 v225, 64, v224
v_xor_b32 v226, 128, v224
v_xor_b32 v227, 192, v224
s_mov_b32 s34, s61
s_add_u32 s61, s61, 16384
s_cmp_ge_u32 s61, 131072
s_cselect_b32 s61, 81920, s61
v_add_u32 v228, s61, v235
v_xor_b32 v229, 64, v228
v_xor_b32 v230, 128, v228
v_xor_b32 v231, 192, v228
v_exp_f32 v105, v105
v_add_f32 v250, v250, v102
v_add_f32 v250, v250, v103
s_waitcnt lgkmcnt(12)
v_mfma_f32_32x32x16_bf16 a[0:15], v[192:195], v[244:247], a[0:15]
ds_read_b64_tr_b16 v[192:193], v224 offset:0
ds_read_b64_tr_b16 v[194:195], v224 offset:2048
s_add_u32 m0, s33, s71
s_add_u32 s7, s30, 131072
buffer_load_dwordx4 v236, s[8:11], s7 offen offset:0 nt lds
v_cvt_pk_bf16_f32 v83, v102, v103
v_fma_f32 v106, v106, s62, -v249
v_fma_f32 v107, v107, s62, -v249
v_exp_f32 v106, v106
v_mfma_f32_32x32x16_bf16 a[16:31], v[196:199], v[244:247], a[16:31]
ds_read_b64_tr_b16 v[196:197], v225 offset:0
ds_read_b64_tr_b16 v[198:199], v225 offset:2048
v_exp_f32 v107, v107
v_add_f32 v250, v250, v104
v_add_f32 v250, v250, v105
s_waitcnt lgkmcnt(12)
v_mfma_f32_32x32x16_bf16 a[32:47], v[200:203], v[244:247], a[32:47]
ds_read_b64_tr_b16 v[200:201], v224 offset:4096
ds_read_b64_tr_b16 v[202:203], v224 offset:6144
v_xor_b32 v240, 64, v236
buffer_load_dwordx4 v240, s[8:11], s7 offen offset:1024 nt lds
v_cvt_pk_bf16_f32 v84, v104, v105
v_fma_f32 v108, v108, s62, -v249
v_fma_f32 v109, v109, s62, -v249
v_exp_f32 v108, v108
v_mfma_f32_32x32x16_bf16 a[48:63], v[204:207], v[244:247], a[48:63]
ds_read_b64_tr_b16 v[204:205], v225 offset:4096
ds_read_b64_tr_b16 v[206:207], v225 offset:6144
v_exp_f32 v109, v109
v_add_f32 v250, v250, v106
v_add_f32 v250, v250, v107
s_waitcnt lgkmcnt(12)
v_mfma_f32_32x32x16_bf16 a[64:79], v[208:211], v[244:247], a[64:79]
ds_read_b64_tr_b16 v[208:209], v226 offset:0
ds_read_b64_tr_b16 v[210:211], v226 offset:2048
v_xor_b32 v240, 128, v236
buffer_load_dwordx4 v240, s[8:11], s7 offen offset:2048 nt lds
v_cvt_pk_bf16_f32 v85, v106, v107
v_fma_f32 v110, v110, s62, -v249
v_fma_f32 v111, v111, s62, -v249
v_exp_f32 v110, v110
v_mfma_f32_32x32x16_bf16 a[80:95], v[212:215], v[244:247], a[80:95]
ds_read_b64_tr_b16 v[212:213], v227 offset:0
ds_read_b64_tr_b16 v[214:215], v227 offset:2048
v_exp_f32 v111, v111
v_add_f32 v250, v250, v108
s_waitcnt lgkmcnt(12)
v_mfma_f32_32x32x16_bf16 a[96:111], v[216:219], v[244:247], a[96:111]
ds_read_b64_tr_b16 v[216:217], v226 offset:4096
ds_read_b64_tr_b16 v[218:219], v226 offset:6144
v_xor_b32 v240, 192, v236
buffer_load_dwordx4 v240, s[8:11], s7 offen offset:3072 nt lds
s_mov_b32 s33, s35
v_add_f32 v250, v250, v109
v_cvt_pk_bf16_f32 v86, v108, v109
s_nop 0
v_mfma_f32_32x32x16_bf16 a[112:127], v[220:223], v[244:247], a[112:127]
ds_read_b64_tr_b16 v[220:221], v227 offset:4096
ds_read_b64_tr_b16 v[222:223], v227 offset:6144
v_add_f32 v250, v250, v110
v_add_f32 v250, v250, v111
v_cvt_pk_bf16_f32 v87, v110, v111
s_waitcnt vmcnt(12)
s_barrier
ds_read_b128 v[244:247], v242 offset:17408
s_waitcnt lgkmcnt(13)
v_mfma_f32_32x32x16_bf16 v[32:47], v[192:195], v[72:75], v[32:47]
ds_read_b64_tr_b16 v[192:193], v228 offset:0
ds_read_b64_tr_b16 v[194:195], v228 offset:4096
s_add_u32 m0, s34, s71
s_add_u32 s3, s31, 114688
buffer_load_dwordx4 v238, s[20:23], s3 offen offset:0 lds
v_fma_f32 v112, v112, s62, -v249
v_fma_f32 v113, v113, s62, -v249
v_exp_f32 v112, v112
v_exp_f32 v113, v113
v_mfma_f32_32x32x16_bf16 v[48:63], v[196:199], v[72:75], v[48:63]
ds_read_b64_tr_b16 v[196:197], v229 offset:0
ds_read_b64_tr_b16 v[198:199], v229 offset:4096
v_fma_f32 v114, v114, s62, -v249
v_fma_f32 v115, v115, s62, -v249
v_exp_f32 v114, v114
v_exp_f32 v115, v115
s_waitcnt lgkmcnt(13)
v_mfma_f32_32x32x16_bf16 v[32:47], v[200:203], v[76:79], v[32:47]
ds_read_b64_tr_b16 v[200:201], v230 offset:0
ds_read_b64_tr_b16 v[202:203], v230 offset:4096
v_xor_b32 v240, 64, v238
buffer_load_dwordx4 v240, s[20:23], s3 offen offset:1024 lds
v_add_f32 v250, v250, v112
v_add_f32 v250, v250, v113
v_cvt_pk_bf16_f32 v88, v112, v113
v_fma_f32 v116, v116, s62, -v249
v_fma_f32 v117, v117, s62, -v249
v_mfma_f32_32x32x16_bf16 v[48:63], v[204:207], v[76:79], v[48:63]
ds_read_b64_tr_b16 v[204:205], v231 offset:0
ds_read_b64_tr_b16 v[206:207], v231 offset:4096
v_exp_f32 v116, v116
v_exp_f32 v117, v117
v_add_f32 v250, v250, v114
s_waitcnt lgkmcnt(13)
v_mfma_f32_32x32x16_bf16 v[160:175], v[208:211], v[72:75], v[160:175]
ds_read_b64_tr_b16 v[208:209], v228 offset:256
ds_read_b64_tr_b16 v[210:211], v228 offset:4352
v_xor_b32 v240, 128, v238
buffer_load_dwordx4 v240, s[20:23], s3 offen offset:2048 lds
v_add_f32 v250, v250, v115
v_cvt_pk_bf16_f32 v89, v114, v115
v_fma_f32 v118, v118, s62, -v249
v_fma_f32 v119, v119, s62, -v249
v_exp_f32 v118, v118
v_mfma_f32_32x32x16_bf16 v[176:191], v[212:215], v[72:75], v[176:191]
ds_read_b64_tr_b16 v[212:213], v229 offset:256
ds_read_b64_tr_b16 v[214:215], v229 offset:4352
v_exp_f32 v119, v119
v_add_f32 v250, v250, v116
v_add_f32 v250, v250, v117
v_cvt_pk_bf16_f32 v90, v116, v117
s_waitcnt lgkmcnt(13)
v_mfma_f32_32x32x16_bf16 v[160:175], v[216:219], v[76:79], v[160:175]
ds_read_b64_tr_b16 v[216:217], v230 offset:256
ds_read_b64_tr_b16 v[218:219], v230 offset:4352
v_xor_b32 v240, 192, v238
buffer_load_dwordx4 v240, s[20:23], s3 offen offset:3072 lds
v_fma_f32 v120, v120, s62, -v249
v_fma_f32 v121, v121, s62, -v249
v_exp_f32 v120, v120
v_mfma_f32_32x32x16_bf16 v[176:191], v[220:223], v[76:79], v[176:191]
ds_read_b64_tr_b16 v[220:221], v231 offset:256
ds_read_b64_tr_b16 v[222:223], v231 offset:4352
s_mov_b32 s35, s60
s_add_u32 s60, s60, 16384
s_cmp_ge_u32 s60, 81920
s_cselect_b32 s60, 0, s60
v_add_u32 v224, s60, v233
v_xor_b32 v225, 64, v224
v_xor_b32 v226, 128, v224
v_xor_b32 v227, 192, v224
s_mov_b32 s34, s61
s_add_u32 s61, s61, 16384
s_cmp_ge_u32 s61, 131072
s_cselect_b32 s61, 81920, s61
v_add_u32 v228, s61, v235
v_xor_b32 v229, 64, v228
v_xor_b32 v230, 128, v228
v_xor_b32 v231, 192, v228
v_exp_f32 v121, v121
v_add_f32 v250, v250, v118
v_add_f32 v250, v250, v119
s_waitcnt lgkmcnt(12)
v_mfma_f32_32x32x16_bf16 a[0:15], v[192:195], v[244:247], a[0:15]
ds_read_b64_tr_b16 v[192:193], v224 offset:0
ds_read_b64_tr_b16 v[194:195], v224 offset:2048
s_add_u32 m0, s33, s71
s_add_u32 s7, s30, 147456
buffer_load_dwordx4 v236, s[8:11], s7 offen offset:0 nt lds
v_cvt_pk_bf16_f32 v91, v118, v119
v_fma_f32 v122, v122, s62, -v249
v_fma_f32 v123, v123, s62, -v249
v_exp_f32 v122, v122
v_mfma_f32_32x32x16_bf16 a[16:31], v[196:199], v[244:247], a[16:31]
ds_read_b64_tr_b16 v[196:197], v225 offset:0
ds_read_b64_tr_b16 v[198:199], v225 offset:2048
v_exp_f32 v123, v123
v_add_f32 v250, v250, v120
v_add_f32 v250, v250, v121
s_waitcnt lgkmcnt(12)
v_mfma_f32_32x32x16_bf16 a[32:47], v[200:203], v[244:247], a[32:47]
ds_read_b64_tr_b16 v[200:201], v224 offset:4096
ds_read_b64_tr_b16 v[202:203], v224 offset:6144
v_xor_b32 v240, 64, v236
buffer_load_dwordx4 v240, s[8:11], s7 offen offset:1024 nt lds
v_cvt_pk_bf16_f32 v92, v120, v121
v_fma_f32 v124, v124, s62, -v249
v_fma_f32 v125, v125, s62, -v249
v_exp_f32 v124, v124
v_mfma_f32_32x32x16_bf16 a[48:63], v[204:207], v[244:247], a[48:63]
ds_read_b64_tr_b16 v[204:205], v225 offset:4096
ds_read_b64_tr_b16 v[206:207], v225 offset:6144
v_exp_f32 v125, v125
v_add_f32 v250, v250, v122
v_add_f32 v250, v250, v123
s_waitcnt lgkmcnt(12)
v_mfma_f32_32x32x16_bf16 a[64:79], v[208:211], v[244:247], a[64:79]
ds_read_b64_tr_b16 v[208:209], v226 offset:0
ds_read_b64_tr_b16 v[210:211], v226 offset:2048
v_xor_b32 v240, 128, v236
buffer_load_dwordx4 v240, s[8:11], s7 offen offset:2048 nt lds
v_cvt_pk_bf16_f32 v93, v122, v123
v_fma_f32 v126, v126, s62, -v249
v_fma_f32 v127, v127, s62, -v249
v_exp_f32 v126, v126
v_mfma_f32_32x32x16_bf16 a[80:95], v[212:215], v[244:247], a[80:95]
ds_read_b64_tr_b16 v[212:213], v227 offset:0
ds_read_b64_tr_b16 v[214:215], v227 offset:2048
v_exp_f32 v127, v127
v_add_f32 v250, v250, v124
s_waitcnt lgkmcnt(12)
v_mfma_f32_32x32x16_bf16 a[96:111], v[216:219], v[244:247], a[96:111]
ds_read_b64_tr_b16 v[216:217], v226 offset:4096
ds_read_b64_tr_b16 v[218:219], v226 offset:6144
v_xor_b32 v240, 192, v236
buffer_load_dwordx4 v240, s[8:11], s7 offen offset:3072 nt lds
s_mov_b32 s33, s35
v_add_f32 v250, v250, v125
v_cvt_pk_bf16_f32 v94, v124, v125
s_nop 0
v_mfma_f32_32x32x16_bf16 a[112:127], v[220:223], v[244:247], a[112:127]
ds_read_b64_tr_b16 v[220:221], v227 offset:4096
ds_read_b64_tr_b16 v[222:223], v227 offset:6144
v_add_f32 v250, v250, v126
v_add_f32 v250, v250, v127
v_cvt_pk_bf16_f32 v95, v126, v127
s_waitcnt vmcnt(12)
s_barrier
ds_read_b128 v[244:247], v242 offset:18432
s_waitcnt lgkmcnt(13)
v_mfma_f32_32x32x16_bf16 v[32:47], v[192:195], v[80:83], v[32:47]
ds_read_b64_tr_b16 v[192:193], v228 offset:0
ds_read_b64_tr_b16 v[194:195], v228 offset:4096
v_mov_b32 v251, v250
v_mov_b32 v252, v249
s_nop 0
v_permlane32_swap_b32 v250, v251
s_add_u32 m0, s34, s71
s_add_u32 s3, s32, 256
buffer_load_dwordx4 v239, s[16:19], s3 offen offset:0 lds
v_mfma_f32_32x32x16_bf16 v[48:63], v[196:199], v[80:83], v[48:63]
ds_read_b64_tr_b16 v[196:197], v229 offset:0
ds_read_b64_tr_b16 v[198:199], v229 offset:4096
v_add_f32 v253, v250, v251
ds_write_b64 v241, v[252:253] offset:4096
s_waitcnt lgkmcnt(14)
v_mfma_f32_32x32x16_bf16 v[32:47], v[200:203], v[84:87], v[32:47]
ds_read_b64_tr_b16 v[200:201], v230 offset:0
ds_read_b64_tr_b16 v[202:203], v230 offset:4096
s_add_u32 s3, s32, 32000
buffer_load_dwordx4 v239, s[16:19], s3 offen offset:1024 lds
v_mfma_f32_32x32x16_bf16 v[48:63], v[204:207], v[84:87], v[48:63]
ds_read_b64_tr_b16 v[204:205], v231 offset:0
ds_read_b64_tr_b16 v[206:207], v231 offset:4096
s_waitcnt lgkmcnt(14)
v_mfma_f32_32x32x16_bf16 v[160:175], v[208:211], v[80:83], v[160:175]
ds_read_b64_tr_b16 v[208:209], v228 offset:256
ds_read_b64_tr_b16 v[210:211], v228 offset:4352
s_add_u32 s3, s32, 63744
buffer_load_dwordx4 v239, s[16:19], s3 offen offset:2048 lds
v_mfma_f32_32x32x16_bf16 v[176:191], v[212:215], v[80:83], v[176:191]
ds_read_b64_tr_b16 v[212:213], v229 offset:256
ds_read_b64_tr_b16 v[214:215], v229 offset:4352
s_waitcnt lgkmcnt(14)
v_mfma_f32_32x32x16_bf16 v[160:175], v[216:219], v[84:87], v[160:175]
ds_read_b64_tr_b16 v[216:217], v230 offset:256
ds_read_b64_tr_b16 v[218:219], v230 offset:4352
s_add_u32 s3, s32, 95488
buffer_load_dwordx4 v239, s[16:19], s3 offen offset:3072 lds
v_mfma_f32_32x32x16_bf16 v[176:191], v[220:223], v[84:87], v[176:191]
ds_read_b64_tr_b16 v[220:221], v231 offset:256
ds_read_b64_tr_b16 v[222:223], v231 offset:4352
s_mov_b32 s35, s60
s_add_u32 s60, s60, 16384
s_cmp_ge_u32 s60, 81920
s_cselect_b32 s60, 0, s60
v_add_u32 v224, s60, v233
v_xor_b32 v225, 64, v224
v_xor_b32 v226, 128, v224
v_xor_b32 v227, 192, v224
s_mov_b32 s34, s61
s_add_u32 s61, s61, 16384
s_cmp_ge_u32 s61, 131072
s_cselect_b32 s61, 81920, s61
v_add_u32 v228, s61, v235
v_xor_b32 v229, 64, v228
v_xor_b32 v230, 128, v228
v_xor_b32 v231, 192, v228
s_waitcnt lgkmcnt(13)
v_mfma_f32_32x32x16_bf16 a[0:15], v[192:195], v[244:247], a[0:15]
ds_read_b64_tr_b16 v[192:193], v224 offset:0
ds_read_b64_tr_b16 v[194:195], v224 offset:2048
s_add_u32 m0, s33, s71
s_add_u32 s7, s30, 163840
buffer_load_dwordx4 v236, s[8:11], s7 offen offset:0 nt lds
v_mfma_f32_32x32x16_bf16 a[16:31], v[196:199], v[244:247], a[16:31]
ds_read_b64_tr_b16 v[196:197], v225 offset:0
ds_read_b64_tr_b16 v[198:199], v225 offset:2048
s_waitcnt lgkmcnt(12)
v_mfma_f32_32x32x16_bf16 a[32:47], v[200:203], v[244:247], a[32:47]
ds_read_b64_tr_b16 v[200:201], v224 offset:4096
ds_read_b64_tr_b16 v[202:203], v224 offset:6144
v_xor_b32 v240, 64, v236
buffer_load_dwordx4 v240, s[8:11], s7 offen offset:1024 nt lds
v_mfma_f32_32x32x16_bf16 a[48:63], v[204:207], v[244:247], a[48:63]
ds_read_b64_tr_b16 v[204:205], v225 offset:4096
ds_read_b64_tr_b16 v[206:207], v225 offset:6144
s_waitcnt lgkmcnt(12)
v_mfma_f32_32x32x16_bf16 a[64:79], v[208:211], v[244:247], a[64:79]
ds_read_b64_tr_b16 v[208:209], v226 offset:0
ds_read_b64_tr_b16 v[210:211], v226 offset:2048
v_xor_b32 v240, 128, v236
buffer_load_dwordx4 v240, s[8:11], s7 offen offset:2048 nt lds
v_mfma_f32_32x32x16_bf16 a[80:95], v[212:215], v[244:247], a[80:95]
ds_read_b64_tr_b16 v[212:213], v227 offset:0
ds_read_b64_tr_b16 v[214:215], v227 offset:2048
s_waitcnt lgkmcnt(12)
v_mfma_f32_32x32x16_bf16 a[96:111], v[216:219], v[244:247], a[96:111]
ds_read_b64_tr_b16 v[216:217], v226 offset:4096
ds_read_b64_tr_b16 v[218:219], v226 offset:6144
v_xor_b32 v240, 192, v236
buffer_load_dwordx4 v240, s[8:11], s7 offen offset:3072 nt lds
s_mov_b32 s33, s35
v_mfma_f32_32x32x16_bf16 a[112:127], v[220:223], v[244:247], a[112:127]
ds_read_b64_tr_b16 v[220:221], v227 offset:4096
ds_read_b64_tr_b16 v[222:223], v227 offset:6144
s_waitcnt vmcnt(12)
s_barrier
ds_read_b128 v[244:247], v242 offset:19456
v_xor_b32 v240, 0x4000, v241
ds_read_b64 v[254:255], v240 offset:4096
s_waitcnt lgkmcnt(14)
v_mfma_f32_32x32x16_bf16 v[32:47], v[192:195], v[88:91], v[32:47]
ds_read_b64_tr_b16 v[192:193], v228 offset:0
ds_read_b64_tr_b16 v[194:195], v228 offset:4096
s_add_u32 m0, s34, s71
s_add_u32 s3, s32, 524544
buffer_load_dwordx4 v239, s[16:19], s3 offen offset:0 lds
v_mfma_f32_32x32x16_bf16 v[48:63], v[196:199], v[88:91], v[48:63]
ds_read_b64_tr_b16 v[196:197], v229 offset:0
ds_read_b64_tr_b16 v[198:199], v229 offset:4096
s_waitcnt lgkmcnt(14)
v_mfma_f32_32x32x16_bf16 v[32:47], v[200:203], v[92:95], v[32:47]
ds_read_b64_tr_b16 v[200:201], v230 offset:0
ds_read_b64_tr_b16 v[202:203], v230 offset:4096
s_add_u32 s3, s32, 556288
buffer_load_dwordx4 v239, s[16:19], s3 offen offset:1024 lds
v_mfma_f32_32x32x16_bf16 v[48:63], v[204:207], v[92:95], v[48:63]
ds_read_b64_tr_b16 v[204:205], v231 offset:0
ds_read_b64_tr_b16 v[206:207], v231 offset:4096
s_waitcnt lgkmcnt(14)
v_mfma_f32_32x32x16_bf16 v[160:175], v[208:211], v[88:91], v[160:175]
ds_read_b64_tr_b16 v[208:209], v228 offset:256
ds_read_b64_tr_b16 v[210:211], v228 offset:4352
s_add_u32 s3, s32, 588032
buffer_load_dwordx4 v239, s[16:19], s3 offen offset:2048 lds
v_mfma_f32_32x32x16_bf16 v[176:191], v[212:215], v[88:91], v[176:191]
ds_read_b64_tr_b16 v[212:213], v229 offset:256
ds_read_b64_tr_b16 v[214:215], v229 offset:4352
s_waitcnt lgkmcnt(14)
v_mfma_f32_32x32x16_bf16 v[160:175], v[216:219], v[92:95], v[160:175]
ds_read_b64_tr_b16 v[216:217], v230 offset:256
ds_read_b64_tr_b16 v[218:219], v230 offset:4352
s_add_u32 s3, s32, 619776
buffer_load_dwordx4 v239, s[16:19], s3 offen offset:3072 lds
v_mfma_f32_32x32x16_bf16 v[176:191], v[220:223], v[92:95], v[176:191]
ds_read_b64_tr_b16 v[220:221], v231 offset:256
ds_read_b64_tr_b16 v[222:223], v231 offset:4352
s_mov_b32 s35, s60
s_add_u32 s60, s60, 16384
s_cmp_ge_u32 s60, 81920
s_cselect_b32 s60, 0, s60
v_add_u32 v224, s60, v232
s_mov_b32 s34, s61
s_add_u32 s61, s61, 16384
s_cmp_ge_u32 s61, 131072
s_cselect_b32 s61, 81920, s61
v_add_u32 v228, s61, v234
v_xor_b32 v229, 64, v228
s_waitcnt lgkmcnt(12)
v_mfma_f32_32x32x16_bf16 a[0:15], v[192:195], v[244:247], a[0:15]
ds_read_b128 v[192:195], v224
s_add_u32 m0, s33, s71
s_add_u32 s7, s30, 180224
buffer_load_dwordx4 v236, s[8:11], s7 offen offset:0 nt lds
v_mfma_f32_32x32x16_bf16 a[16:31], v[196:199], v[244:247], a[16:31]
v_xor_b32 v226, 32, v224
ds_read_b128 v[196:199], v226
s_waitcnt lgkmcnt(10)
v_mfma_f32_32x32x16_bf16 a[32:47], v[200:203], v[244:247], a[32:47]
v_xor_b32 v225, 64, v224
ds_read_b128 v[200:203], v225
v_xor_b32 v240, 64, v236
buffer_load_dwordx4 v240, s[8:11], s7 offen offset:1024 nt lds
v_mfma_f32_32x32x16_bf16 a[48:63], v[204:207], v[244:247], a[48:63]
v_xor_b32 v226, 96, v224
ds_read_b128 v[204:207], v226
s_waitcnt lgkmcnt(8)
v_mfma_f32_32x32x16_bf16 a[64:79], v[208:211], v[244:247], a[64:79]
v_xor_b32 v225, 128, v224
ds_read_b128 v[208:211], v225
v_xor_b32 v240, 128, v236
buffer_load_dwordx4 v240, s[8:11], s7 offen offset:2048 nt lds
v_mfma_f32_32x32x16_bf16 a[80:95], v[212:215], v[244:247], a[80:95]
v_xor_b32 v226, 160, v224
ds_read_b128 v[212:215], v226
s_waitcnt lgkmcnt(6)
v_mfma_f32_32x32x16_bf16 a[96:111], v[216:219], v[244:247], a[96:111]
v_xor_b32 v225, 192, v224
ds_read_b128 v[216:219], v225
v_xor_b32 v240, 192, v236
buffer_load_dwordx4 v240, s[8:11], s7 offen offset:3072 nt lds
s_mov_b32 s33, s35
v_mfma_f32_32x32x16_bf16 a[112:127], v[220:223], v[244:247], a[112:127]
v_xor_b32 v226, 224, v224
ds_read_b128 v[220:223], v226
s_add_u32 s30, s30, 131072
s_add_u32 s31, s31, 131072
s_add_u32 s32, s32, 256
s_add_u32 s29, s29, 1
s_cmp_ge_u32 s29, 7
s_cselect_b32 s32, 0x80000000, s32
s_cmp_lt_u32 s29, 8
s_cbranch_scc1 L_head
s_waitcnt vmcnt(4)
s_waitcnt lgkmcnt(0)
s_barrier
v_xor_b32 v240, 0x4000, v241
ds_write_b128 v240, v[160:163] offset:0
ds_write_b128 v240, v[164:167] offset:1024
ds_write_b128 v240, v[168:171] offset:2048
ds_write_b128 v240, v[172:175] offset:3072
ds_write_b128 v240, v[176:179] offset:4096
ds_write_b128 v240, v[180:183] offset:5120
ds_write_b128 v240, v[184:187] offset:6144
ds_write_b128 v240, v[188:191] offset:7168
s_add_u32 m0, s71, 32768
s_add_u32 s3, s31, 65536
buffer_load_dwordx4 v238, s[20:23], s3 offen offset:0 lds
v_xor_b32 v240, 64, v238
buffer_load_dwordx4 v240, s[20:23], s3 offen offset:1024 lds
v_xor_b32 v240, 128, v238
buffer_load_dwordx4 v240, s[20:23], s3 offen offset:2048 lds
v_xor_b32 v240, 192, v238
buffer_load_dwordx4 v240, s[20:23], s3 offen offset:3072 lds
s_add_u32 m0, s71, 81920
s_add_u32 s3, s31, 81920
buffer_load_dwordx4 v238, s[20:23], s3 offen offset:0 lds
v_xor_b32 v240, 64, v238
buffer_load_dwordx4 v240, s[20:23], s3 offen offset:1024 lds
v_xor_b32 v240, 128, v238
buffer_load_dwordx4 v240, s[20:23], s3 offen offset:2048 lds
v_xor_b32 v240, 192, v238
buffer_load_dwordx4 v240, s[20:23], s3 offen offset:3072 lds
s_add_u32 m0, s71, 98304
s_add_u32 s3, s31, 98304
buffer_load_dwordx4 v238, s[20:23], s3 offen offset:0 lds
v_xor_b32 v240, 64, v238
buffer_load_dwordx4 v240, s[20:23], s3 offen offset:1024 lds
v_xor_b32 v240, 128, v238
buffer_load_dwordx4 v240, s[20:23], s3 offen offset:2048 lds
v_xor_b32 v240, 192, v238
buffer_load_dwordx4 v240, s[20:23], s3 offen offset:3072 lds
s_add_u32 m0, s71, 114688
s_add_u32 s3, s31, 114688
buffer_load_dwordx4 v238, s[20:23], s3 offen offset:0 lds
v_xor_b32 v240, 64, v238
buffer_load_dwordx4 v240, s[20:23], s3 offen offset:1024 lds
v_xor_b32 v240, 128, v238
buffer_load_dwordx4 v240, s[20:23], s3 offen offset:2048 lds
v_xor_b32 v240, 192, v238
buffer_load_dwordx4 v240, s[20:23], s3 offen offset:3072 lds
v_max_f32 v251, v252, v254
v_sub_f32 v252, v252, v251
v_sub_f32 v254, v254, v251
v_exp_f32 v252, v252
v_exp_f32 v254, v254
s_nop 0
v_mul_f32 v253, v253, v252
v_fma_f32 v253, v255, v254, v253
v_rcp_f32 v253, v253
s_nop 0
v_mul_f32 v252, v252, v253
v_mul_f32 v253, v254, v253
s_waitcnt lgkmcnt(0)
s_barrier
ds_read_b128 v[64:67], v241 offset:0
ds_read_b128 v[68:71], v241 offset:1024
ds_read_b128 v[72:75], v241 offset:2048
ds_read_b128 v[76:79], v241 offset:3072
ds_read_b128 v[80:83], v241 offset:4096
ds_read_b128 v[84:87], v241 offset:5120
ds_read_b128 v[88:91], v241 offset:6144
ds_read_b128 v[92:95], v241 offset:7168
s_waitcnt lgkmcnt(0)
v_mul_f32 v32, v32, v252
v_fma_f32 v32, v64, v253, v32
v_mul_f32 v33, v33, v252
v_fma_f32 v33, v65, v253, v33
v_cvt_pk_bf16_f32 v96, v32, v33
v_mul_f32 v34, v34, v252
v_fma_f32 v34, v66, v253, v34
v_mul_f32 v35, v35, v252
v_fma_f32 v35, v67, v253, v35
v_cvt_pk_bf16_f32 v97, v34, v35
v_mul_f32 v36, v36, v252
v_fma_f32 v36, v68, v253, v36
v_mul_f32 v37, v37, v252
v_fma_f32 v37, v69, v253, v37
v_cvt_pk_bf16_f32 v98, v36, v37
v_mul_f32 v38, v38, v252
v_fma_f32 v38, v70, v253, v38
v_mul_f32 v39, v39, v252
v_fma_f32 v39, v71, v253, v39
v_cvt_pk_bf16_f32 v99, v38, v39
ds_write_b128 v241, v[96:99] offset:0
v_mul_f32 v40, v40, v252
v_fma_f32 v40, v72, v253, v40
v_mul_f32 v41, v41, v252
v_fma_f32 v41, v73, v253, v41
v_cvt_pk_bf16_f32 v100, v40, v41
v_mul_f32 v42, v42, v252
v_fma_f32 v42, v74, v253, v42
v_mul_f32 v43, v43, v252
v_fma_f32 v43, v75, v253, v43
v_cvt_pk_bf16_f32 v101, v42, v43
v_mul_f32 v44, v44, v252
v_fma_f32 v44, v76, v253, v44
v_mul_f32 v45, v45, v252
v_fma_f32 v45, v77, v253, v45
v_cvt_pk_bf16_f32 v102, v44, v45
v_mul_f32 v46, v46, v252
v_fma_f32 v46, v78, v253, v46
v_mul_f32 v47, v47, v252
v_fma_f32 v47, v79, v253, v47
v_cvt_pk_bf16_f32 v103, v46, v47
ds_write_b128 v241, v[100:103] offset:1024
v_mul_f32 v48, v48, v252
v_fma_f32 v48, v80, v253, v48
v_mul_f32 v49, v49, v252
v_fma_f32 v49, v81, v253, v49
v_cvt_pk_bf16_f32 v104, v48, v49
v_mul_f32 v50, v50, v252
v_fma_f32 v50, v82, v253, v50
v_mul_f32 v51, v51, v252
v_fma_f32 v51, v83, v253, v51
v_cvt_pk_bf16_f32 v105, v50, v51
v_mul_f32 v52, v52, v252
v_fma_f32 v52, v84, v253, v52
v_mul_f32 v53, v53, v252
v_fma_f32 v53, v85, v253, v53
v_cvt_pk_bf16_f32 v106, v52, v53
v_mul_f32 v54, v54, v252
v_fma_f32 v54, v86, v253, v54
v_mul_f32 v55, v55, v252
v_fma_f32 v55, v87, v253, v55
v_cvt_pk_bf16_f32 v107, v54, v55
ds_write_b128 v241, v[104:107] offset:2048
v_mul_f32 v56, v56, v252
v_fma_f32 v56, v88, v253, v56
v_mul_f32 v57, v57, v252
v_fma_f32 v57, v89, v253, v57
v_cvt_pk_bf16_f32 v108, v56, v57
v_mul_f32 v58, v58, v252
v_fma_f32 v58, v90, v253, v58
v_mul_f32 v59, v59, v252
v_fma_f32 v59, v91, v253, v59
v_cvt_pk_bf16_f32 v109, v58, v59
v_mul_f32 v60, v60, v252
v_fma_f32 v60, v92, v253, v60
v_mul_f32 v61, v61, v252
v_fma_f32 v61, v93, v253, v61
v_cvt_pk_bf16_f32 v110, v60, v61
v_mul_f32 v62, v62, v252
v_fma_f32 v62, v94, v253, v62
v_mul_f32 v63, v63, v252
v_fma_f32 v63, v95, v253, v63
v_cvt_pk_bf16_f32 v111, v62, v63
ds_write_b128 v241, v[108:111] offset:3072
s_waitcnt vmcnt(0) lgkmcnt(0)
s_barrier
ds_read_b128 v[128:131], v242 offset:0
ds_read_b128 v[132:135], v242 offset:1024
ds_read_b128 v[136:139], v242 offset:2048
ds_read_b128 v[140:143], v242 offset:3072
ds_read_b128 v[144:147], v242 offset:16384
ds_read_b128 v[148:151], v242 offset:17408
ds_read_b128 v[152:155], v242 offset:18432
ds_read_b128 v[156:159], v242 offset:19456
v_mov_b32 v228, v235
v_add_u32 v224, 0x10000, v235
v_xor_b32 v229, 64, v228
v_xor_b32 v225, 64, v224
v_xor_b32 v230, 128, v228
v_xor_b32 v226, 128, v224
v_xor_b32 v231, 192, v228
v_xor_b32 v227, 192, v224
s_mov_b32 s24, s58
s_mov_b32 s25, s59
s_mov_b32 s26, 0x2000000
s_mov_b32 s27, 0x20000
s_lshl_b32 s63, s69, 5
s_add_u32 s63, s63, s67
s_lshl_b32 s63, s63, 2
s_add_u32 s63, s63, s68
s_lshl_b32 s63, s63, 16
s_lshl_b32 s64, s65, 14
s_add_u32 s5, s63, s64
ds_read_b64_tr_b16 v[192:193], v228 offset:49152
ds_read_b64_tr_b16 v[194:195], v228 offset:53248
ds_read_b64_tr_b16 v[196:197], v224 offset:0
ds_read_b64_tr_b16 v[198:199], v224 offset:4096
ds_read_b64_tr_b16 v[200:201], v228 offset:0
ds_read_b64_tr_b16 v[202:203], v228 offset:4096
ds_read_b64_tr_b16 v[204:205], v228 offset:16384
ds_read_b64_tr_b16 v[206:207], v228 offset:20480
ds_read_b64_tr_b16 v[208:209], v228 offset:32768
ds_read_b64_tr_b16 v[210:211], v228 offset:36864
ds_read_b64_tr_b16 v[212:213], v224 offset:16384
ds_read_b64_tr_b16 v[214:215], v224 offset:20480
ds_read_b64_tr_b16 v[216:217], v224 offset:32768
ds_read_b64_tr_b16 v[218:219], v224 offset:36864
s_waitcnt lgkmcnt(12)
v_mfma_f32_32x32x16_bf16 a[0:15], v[192:195], v[128:131], a[0:15]
ds_read_b64_tr_b16 v[220:221], v224 offset:49152
ds_read_b64_tr_b16 v[222:223], v224 offset:53248
s_waitcnt lgkmcnt(12)
v_mfma_f32_32x32x16_bf16 a[0:15], v[196:199], v[132:135], a[0:15]
ds_read_b64_tr_b16 v[192:193], v229 offset:49152
ds_read_b64_tr_b16 v[194:195], v229 offset:53248
s_waitcnt lgkmcnt(12)
v_mfma_f32_32x32x16_bf16 a[0:15], v[200:203], v[136:139], a[0:15]
ds_read_b64_tr_b16 v[196:197], v225 offset:0
ds_read_b64_tr_b16 v[198:199], v225 offset:4096
s_waitcnt lgkmcnt(12)
v_mfma_f32_32x32x16_bf16 a[0:15], v[204:207], v[140:143], a[0:15]
ds_read_b64_tr_b16 v[200:201], v229 offset:0
ds_read_b64_tr_b16 v[202:203], v229 offset:4096
s_waitcnt lgkmcnt(12)
v_mfma_f32_32x32x16_bf16 a[0:15], v[208:211], v[144:147], a[0:15]
ds_read_b64_tr_b16 v[204:205], v229 offset:16384
ds_read_b64_tr_b16 v[206:207], v229 offset:20480
s_waitcnt lgkmcnt(12)
v_mfma_f32_32x32x16_bf16 a[0:15], v[212:215], v[148:151], a[0:15]
ds_read_b64_tr_b16 v[208:209], v229 offset:32768
ds_read_b64_tr_b16 v[210:211], v229 offset:36864
s_waitcnt lgkmcnt(12)
v_mfma_f32_32x32x16_bf16 a[0:15], v[216:219], v[152:155], a[0:15]
ds_read_b64_tr_b16 v[212:213], v225 offset:16384
ds_read_b64_tr_b16 v[214:215], v225 offset:20480
s_waitcnt lgkmcnt(12)
v_mfma_f32_32x32x16_bf16 a[0:15], v[220:223], v[156:159], a[0:15]
ds_read_b64_tr_b16 v[216:217], v225 offset:32768
ds_read_b64_tr_b16 v[218:219], v225 offset:36864
s_waitcnt lgkmcnt(12)
v_mfma_f32_32x32x16_bf16 a[16:31], v[192:195], v[128:131], a[16:31]
ds_read_b64_tr_b16 v[220:221], v225 offset:49152
ds_read_b64_tr_b16 v[222:223], v225 offset:53248
s_waitcnt lgkmcnt(12)
v_mfma_f32_32x32x16_bf16 a[16:31], v[196:199], v[132:135], a[16:31]
ds_read_b64_tr_b16 v[192:193], v230 offset:49152
ds_read_b64_tr_b16 v[194:195], v230 offset:53248
s_waitcnt lgkmcnt(12)
v_mfma_f32_32x32x16_bf16 a[16:31], v[200:203], v[136:139], a[16:31]
ds_read_b64_tr_b16 v[196:197], v226 offset:0
ds_read_b64_tr_b16 v[198:199], v226 offset:4096
s_waitcnt lgkmcnt(12)
v_mfma_f32_32x32x16_bf16 a[16:31], v[204:207], v[140:143], a[16:31]
ds_read_b64_tr_b16 v[200:201], v230 offset:0
ds_read_b64_tr_b16 v[202:203], v230 offset:4096
v_accvgpr_read_b32 v0, a0
v_accvgpr_read_b32 v1, a1
v_accvgpr_read_b32 v2, a2
v_accvgpr_read_b32 v3, a3
v_cvt_pk_bf16_f32 v16, v0, v1
v_cvt_pk_bf16_f32 v17, v2, v3
s_waitcnt lgkmcnt(12)
v_mfma_f32_32x32x16_bf16 a[16:31], v[208:211], v[144:147], a[16:31]
ds_read_b64_tr_b16 v[204:205], v230 offset:16384
ds_read_b64_tr_b16 v[206:207], v230 offset:20480
v_accvgpr_read_b32 v4, a4
v_accvgpr_read_b32 v5, a5
v_accvgpr_read_b32 v6, a6
v_accvgpr_read_b32 v7, a7
v_cvt_pk_bf16_f32 v18, v4, v5
v_cvt_pk_bf16_f32 v19, v6, v7
s_add_u32 s63, s5, 0
buffer_store_dwordx4 v[16:19], v238, s[24:27], s63 offen offset:0
s_waitcnt lgkmcnt(12)
v_mfma_f32_32x32x16_bf16 a[16:31], v[212:215], v[148:151], a[16:31]
ds_read_b64_tr_b16 v[208:209], v230 offset:32768
ds_read_b64_tr_b16 v[210:211], v230 offset:36864
v_accvgpr_read_b32 v8, a8
v_accvgpr_read_b32 v9, a9
v_accvgpr_read_b32 v10, a10
v_accvgpr_read_b32 v11, a11
v_cvt_pk_bf16_f32 v20, v8, v9
v_cvt_pk_bf16_f32 v21, v10, v11
s_waitcnt lgkmcnt(12)
v_mfma_f32_32x32x16_bf16 a[16:31], v[216:219], v[152:155], a[16:31]
ds_read_b64_tr_b16 v[212:213], v226 offset:16384
ds_read_b64_tr_b16 v[214:215], v226 offset:20480
v_accvgpr_read_b32 v12, a12
v_accvgpr_read_b32 v13, a13
v_accvgpr_read_b32 v14, a14
v_accvgpr_read_b32 v15, a15
v_cvt_pk_bf16_f32 v22, v12, v13
v_cvt_pk_bf16_f32 v23, v14, v15
s_add_u32 s63, s5, 0
buffer_store_dwordx4 v[20:23], v238, s[24:27], s63 offen offset:1024
s_waitcnt lgkmcnt(12)
v_mfma_f32_32x32x16_bf16 a[16:31], v[220:223], v[156:159], a[16:31]
ds_read_b64_tr_b16 v[216:217], v226 offset:32768
ds_read_b64_tr_b16 v[218:219], v226 offset:36864
s_waitcnt lgkmcnt(12)
v_mfma_f32_32x32x16_bf16 a[32:47], v[192:195], v[128:131], a[32:47]
ds_read_b64_tr_b16 v[220:221], v226 offset:49152
ds_read_b64_tr_b16 v[222:223], v226 offset:53248
s_waitcnt lgkmcnt(12)
v_mfma_f32_32x32x16_bf16 a[32:47], v[196:199], v[132:135], a[32:47]
ds_read_b64_tr_b16 v[192:193], v231 offset:49152
ds_read_b64_tr_b16 v[194:195], v231 offset:53248
s_waitcnt lgkmcnt(12)
v_mfma_f32_32x32x16_bf16 a[32:47], v[200:203], v[136:139], a[32:47]
ds_read_b64_tr_b16 v[196:197], v227 offset:0
ds_read_b64_tr_b16 v[198:199], v227 offset:4096
s_waitcnt lgkmcnt(12)
v_mfma_f32_32x32x16_bf16 a[32:47], v[204:207], v[140:143], a[32:47]
ds_read_b64_tr_b16 v[200:201], v231 offset:0
ds_read_b64_tr_b16 v[202:203], v231 offset:4096
v_accvgpr_read_b32 v32, a16
v_accvgpr_read_b32 v33, a17
v_accvgpr_read_b32 v34, a18
v_accvgpr_read_b32 v35, a19
v_cvt_pk_bf16_f32 v48, v32, v33
v_cvt_pk_bf16_f32 v49, v34, v35
s_waitcnt lgkmcnt(12)
v_mfma_f32_32x32x16_bf16 a[32:47], v[208:211], v[144:147], a[32:47]
ds_read_b64_tr_b16 v[204:205], v231 offset:16384
ds_read_b64_tr_b16 v[206:207], v231 offset:20480
v_accvgpr_read_b32 v36, a20
v_accvgpr_read_b32 v37, a21
v_accvgpr_read_b32 v38, a22
v_accvgpr_read_b32 v39, a23
v_cvt_pk_bf16_f32 v50, v36, v37
v_cvt_pk_bf16_f32 v51, v38, v39
s_add_u32 s63, s5, 2048
buffer_store_dwordx4 v[48:51], v238, s[24:27], s63 offen offset:0
s_waitcnt lgkmcnt(12)
v_mfma_f32_32x32x16_bf16 a[32:47], v[212:215], v[148:151], a[32:47]
ds_read_b64_tr_b16 v[208:209], v231 offset:32768
ds_read_b64_tr_b16 v[210:211], v231 offset:36864
v_accvgpr_read_b32 v40, a24
v_accvgpr_read_b32 v41, a25
v_accvgpr_read_b32 v42, a26
v_accvgpr_read_b32 v43, a27
v_cvt_pk_bf16_f32 v52, v40, v41
v_cvt_pk_bf16_f32 v53, v42, v43
s_waitcnt lgkmcnt(12)
v_mfma_f32_32x32x16_bf16 a[32:47], v[216:219], v[152:155], a[32:47]
ds_read_b64_tr_b16 v[212:213], v227 offset:16384
ds_read_b64_tr_b16 v[214:215], v227 offset:20480
v_accvgpr_read_b32 v44, a28
v_accvgpr_read_b32 v45, a29
v_accvgpr_read_b32 v46, a30
v_accvgpr_read_b32 v47, a31
v_cvt_pk_bf16_f32 v54, v44, v45
v_cvt_pk_bf16_f32 v55, v46, v47
s_add_u32 s63, s5, 2048
buffer_store_dwordx4 v[52:55], v238, s[24:27], s63 offen offset:1024
s_waitcnt lgkmcnt(12)
v_mfma_f32_32x32x16_bf16 a[32:47], v[220:223], v[156:159], a[32:47]
ds_read_b64_tr_b16 v[216:217], v227 offset:32768
ds_read_b64_tr_b16 v[218:219], v227 offset:36864
s_waitcnt lgkmcnt(12)
v_mfma_f32_32x32x16_bf16 a[48:63], v[192:195], v[128:131], a[48:63]
ds_read_b64_tr_b16 v[220:221], v227 offset:49152
ds_read_b64_tr_b16 v[222:223], v227 offset:53248
s_waitcnt lgkmcnt(12)
v_mfma_f32_32x32x16_bf16 a[48:63], v[196:199], v[132:135], a[48:63]
ds_read_b64_tr_b16 v[192:193], v228 offset:49408
ds_read_b64_tr_b16 v[194:195], v228 offset:53504
s_waitcnt lgkmcnt(12)
v_mfma_f32_32x32x16_bf16 a[48:63], v[200:203], v[136:139], a[48:63]
ds_read_b64_tr_b16 v[196:197], v224 offset:256
ds_read_b64_tr_b16 v[198:199], v224 offset:4352
s_waitcnt lgkmcnt(12)
v_mfma_f32_32x32x16_bf16 a[48:63], v[204:207], v[140:143], a[48:63]
ds_read_b64_tr_b16 v[200:201], v228 offset:256
ds_read_b64_tr_b16 v[202:203], v228 offset:4352
v_accvgpr_read_b32 v0, a32
v_accvgpr_read_b32 v1, a33
v_accvgpr_read_b32 v2, a34
v_accvgpr_read_b32 v3, a35
v_cvt_pk_bf16_f32 v16, v0, v1
v_cvt_pk_bf16_f32 v17, v2, v3
s_waitcnt lgkmcnt(12)
v_mfma_f32_32x32x16_bf16 a[48:63], v[208:211], v[144:147], a[48:63]
ds_read_b64_tr_b16 v[204:205], v228 offset:16640
ds_read_b64_tr_b16 v[206:207], v228 offset:20736
v_accvgpr_read_b32 v4, a36
v_accvgpr_read_b32 v5, a37
v_accvgpr_read_b32 v6, a38
v_accvgpr_read_b32 v7, a39
v_cvt_pk_bf16_f32 v18, v4, v5
v_cvt_pk_bf16_f32 v19, v6, v7
s_add_u32 s63, s5, 4096
buffer_store_dwordx4 v[16:19], v238, s[24:27], s63 offen offset:0
s_waitcnt lgkmcnt(12)
v_mfma_f32_32x32x16_bf16 a[48:63], v[212:215], v[148:151], a[48:63]
ds_read_b64_tr_b16 v[208:209], v228 offset:33024
ds_read_b64_tr_b16 v[210:211], v228 offset:37120
v_accvgpr_read_b32 v8, a40
v_accvgpr_read_b32 v9, a41
v_accvgpr_read_b32 v10, a42
v_accvgpr_read_b32 v11, a43
v_cvt_pk_bf16_f32 v20, v8, v9
v_cvt_pk_bf16_f32 v21, v10, v11
s_waitcnt lgkmcnt(12)
v_mfma_f32_32x32x16_bf16 a[48:63], v[216:219], v[152:155], a[48:63]
ds_read_b64_tr_b16 v[212:213], v224 offset:16640
ds_read_b64_tr_b16 v[214:215], v224 offset:20736
v_accvgpr_read_b32 v12, a44
v_accvgpr_read_b32 v13, a45
v_accvgpr_read_b32 v14, a46
v_accvgpr_read_b32 v15, a47
v_cvt_pk_bf16_f32 v22, v12, v13
v_cvt_pk_bf16_f32 v23, v14, v15
s_add_u32 s63, s5, 4096
buffer_store_dwordx4 v[20:23], v238, s[24:27], s63 offen offset:1024
s_waitcnt lgkmcnt(12)
v_mfma_f32_32x32x16_bf16 a[48:63], v[220:223], v[156:159], a[48:63]
ds_read_b64_tr_b16 v[216:217], v224 offset:33024
ds_read_b64_tr_b16 v[218:219], v224 offset:37120
s_waitcnt lgkmcnt(12)
v_mfma_f32_32x32x16_bf16 a[64:79], v[192:195], v[128:131], a[64:79]
ds_read_b64_tr_b16 v[220:221], v224 offset:49408
ds_read_b64_tr_b16 v[222:223], v224 offset:53504
s_waitcnt lgkmcnt(12)
v_mfma_f32_32x32x16_bf16 a[64:79], v[196:199], v[132:135], a[64:79]
ds_read_b64_tr_b16 v[192:193], v229 offset:49408
ds_read_b64_tr_b16 v[194:195], v229 offset:53504
s_waitcnt lgkmcnt(12)
v_mfma_f32_32x32x16_bf16 a[64:79], v[200:203], v[136:139], a[64:79]
ds_read_b64_tr_b16 v[196:197], v225 offset:256
ds_read_b64_tr_b16 v[198:199], v225 offset:4352
s_waitcnt lgkmcnt(12)
v_mfma_f32_32x32x16_bf16 a[64:79], v[204:207], v[140:143], a[64:79]
ds_read_b64_tr_b16 v[200:201], v229 offset:256
ds_read_b64_tr_b16 v[202:203], v229 offset:4352
v_accvgpr_read_b32 v32, a48
v_accvgpr_read_b32 v33, a49
v_accvgpr_read_b32 v34, a50
v_accvgpr_read_b32 v35, a51
v_cvt_pk_bf16_f32 v48, v32, v33
v_cvt_pk_bf16_f32 v49, v34, v35
s_waitcnt lgkmcnt(12)
v_mfma_f32_32x32x16_bf16 a[64:79], v[208:211], v[144:147], a[64:79]
ds_read_b64_tr_b16 v[204:205], v229 offset:16640
ds_read_b64_tr_b16 v[206:207], v229 offset:20736
v_accvgpr_read_b32 v36, a52
v_accvgpr_read_b32 v37, a53
v_accvgpr_read_b32 v38, a54
v_accvgpr_read_b32 v39, a55
v_cvt_pk_bf16_f32 v50, v36, v37
v_cvt_pk_bf16_f32 v51, v38, v39
s_add_u32 s63, s5, 6144
buffer_store_dwordx4 v[48:51], v238, s[24:27], s63 offen offset:0
s_waitcnt lgkmcnt(12)
v_mfma_f32_32x32x16_bf16 a[64:79], v[212:215], v[148:151], a[64:79]
ds_read_b64_tr_b16 v[208:209], v229 offset:33024
ds_read_b64_tr_b16 v[210:211], v229 offset:37120
v_accvgpr_read_b32 v40, a56
v_accvgpr_read_b32 v41, a57
v_accvgpr_read_b32 v42, a58
v_accvgpr_read_b32 v43, a59
v_cvt_pk_bf16_f32 v52, v40, v41
v_cvt_pk_bf16_f32 v53, v42, v43
s_waitcnt lgkmcnt(12)
v_mfma_f32_32x32x16_bf16 a[64:79], v[216:219], v[152:155], a[64:79]
ds_read_b64_tr_b16 v[212:213], v225 offset:16640
ds_read_b64_tr_b16 v[214:215], v225 offset:20736
v_accvgpr_read_b32 v44, a60
v_accvgpr_read_b32 v45, a61
v_accvgpr_read_b32 v46, a62
v_accvgpr_read_b32 v47, a63
v_cvt_pk_bf16_f32 v54, v44, v45
v_cvt_pk_bf16_f32 v55, v46, v47
s_add_u32 s63, s5, 6144
buffer_store_dwordx4 v[52:55], v238, s[24:27], s63 offen offset:1024
s_waitcnt lgkmcnt(12)
v_mfma_f32_32x32x16_bf16 a[64:79], v[220:223], v[156:159], a[64:79]
ds_read_b64_tr_b16 v[216:217], v225 offset:33024
ds_read_b64_tr_b16 v[218:219], v225 offset:37120
s_waitcnt lgkmcnt(12)
v_mfma_f32_32x32x16_bf16 a[80:95], v[192:195], v[128:131], a[80:95]
ds_read_b64_tr_b16 v[220:221], v225 offset:49408
ds_read_b64_tr_b16 v[222:223], v225 offset:53504
s_waitcnt lgkmcnt(12)
v_mfma_f32_32x32x16_bf16 a[80:95], v[196:199], v[132:135], a[80:95]
ds_read_b64_tr_b16 v[192:193], v230 offset:49408
ds_read_b64_tr_b16 v[194:195], v230 offset:53504
s_waitcnt lgkmcnt(12)
v_mfma_f32_32x32x16_bf16 a[80:95], v[200:203], v[136:139], a[80:95]
ds_read_b64_tr_b16 v[196:197], v226 offset:256
ds_read_b64_tr_b16 v[198:199], v226 offset:4352
s_waitcnt lgkmcnt(12)
v_mfma_f32_32x32x16_bf16 a[80:95], v[204:207], v[140:143], a[80:95]
ds_read_b64_tr_b16 v[200:201], v230 offset:256
ds_read_b64_tr_b16 v[202:203], v230 offset:4352
v_accvgpr_read_b32 v0, a64
v_accvgpr_read_b32 v1, a65
v_accvgpr_read_b32 v2, a66
v_accvgpr_read_b32 v3, a67
v_cvt_pk_bf16_f32 v16, v0, v1
v_cvt_pk_bf16_f32 v17, v2, v3
s_waitcnt lgkmcnt(12)
v_mfma_f32_32x32x16_bf16 a[80:95], v[208:211], v[144:147], a[80:95]
ds_read_b64_tr_b16 v[204:205], v230 offset:16640
ds_read_b64_tr_b16 v[206:207], v230 offset:20736
v_accvgpr_read_b32 v4, a68
v_accvgpr_read_b32 v5, a69
v_accvgpr_read_b32 v6, a70
v_accvgpr_read_b32 v7, a71
v_cvt_pk_bf16_f32 v18, v4, v5
v_cvt_pk_bf16_f32 v19, v6, v7
s_add_u32 s63, s5, 8192
buffer_store_dwordx4 v[16:19], v238, s[24:27], s63 offen offset:0
s_waitcnt lgkmcnt(12)
v_mfma_f32_32x32x16_bf16 a[80:95], v[212:215], v[148:151], a[80:95]
ds_read_b64_tr_b16 v[208:209], v230 offset:33024
ds_read_b64_tr_b16 v[210:211], v230 offset:37120
v_accvgpr_read_b32 v8, a72
v_accvgpr_read_b32 v9, a73
v_accvgpr_read_b32 v10, a74
v_accvgpr_read_b32 v11, a75
v_cvt_pk_bf16_f32 v20, v8, v9
v_cvt_pk_bf16_f32 v21, v10, v11
s_waitcnt lgkmcnt(12)
v_mfma_f32_32x32x16_bf16 a[80:95], v[216:219], v[152:155], a[80:95]
ds_read_b64_tr_b16 v[212:213], v226 offset:16640
ds_read_b64_tr_b16 v[214:215], v226 offset:20736
v_accvgpr_read_b32 v12, a76
v_accvgpr_read_b32 v13, a77
v_accvgpr_read_b32 v14, a78
v_accvgpr_read_b32 v15, a79
v_cvt_pk_bf16_f32 v22, v12, v13
v_cvt_pk_bf16_f32 v23, v14, v15
s_add_u32 s63, s5, 8192
buffer_store_dwordx4 v[20:23], v238, s[24:27], s63 offen offset:1024
s_waitcnt lgkmcnt(12)
v_mfma_f32_32x32x16_bf16 a[80:95], v[220:223], v[156:159], a[80:95]
ds_read_b64_tr_b16 v[216:217], v226 offset:33024
ds_read_b64_tr_b16 v[218:219], v226 offset:37120
s_waitcnt lgkmcnt(12)
v_mfma_f32_32x32x16_bf16 a[96:111], v[192:195], v[128:131], a[96:111]
ds_read_b64_tr_b16 v[220:221], v226 offset:49408
ds_read_b64_tr_b16 v[222:223], v226 offset:53504
s_waitcnt lgkmcnt(12)
v_mfma_f32_32x32x16_bf16 a[96:111], v[196:199], v[132:135], a[96:111]
ds_read_b64_tr_b16 v[192:193], v231 offset:49408
ds_read_b64_tr_b16 v[194:195], v231 offset:53504
s_waitcnt lgkmcnt(12)
v_mfma_f32_32x32x16_bf16 a[96:111], v[200:203], v[136:139], a[96:111]
ds_read_b64_tr_b16 v[196:197], v227 offset:256
ds_read_b64_tr_b16 v[198:199], v227 offset:4352
s_waitcnt lgkmcnt(12)
v_mfma_f32_32x32x16_bf16 a[96:111], v[204:207], v[140:143], a[96:111]
ds_read_b64_tr_b16 v[200:201], v231 offset:256
ds_read_b64_tr_b16 v[202:203], v231 offset:4352
v_accvgpr_read_b32 v32, a80
v_accvgpr_read_b32 v33, a81
v_accvgpr_read_b32 v34, a82
v_accvgpr_read_b32 v35, a83
v_cvt_pk_bf16_f32 v48, v32, v33
v_cvt_pk_bf16_f32 v49, v34, v35
s_waitcnt lgkmcnt(12)
v_mfma_f32_32x32x16_bf16 a[96:111], v[208:211], v[144:147], a[96:111]
ds_read_b64_tr_b16 v[204:205], v231 offset:16640
ds_read_b64_tr_b16 v[206:207], v231 offset:20736
v_accvgpr_read_b32 v36, a84
v_accvgpr_read_b32 v37, a85
v_accvgpr_read_b32 v38, a86
v_accvgpr_read_b32 v39, a87
v_cvt_pk_bf16_f32 v50, v36, v37
v_cvt_pk_bf16_f32 v51, v38, v39
s_add_u32 s63, s5, 10240
buffer_store_dwordx4 v[48:51], v238, s[24:27], s63 offen offset:0
s_waitcnt lgkmcnt(12)
v_mfma_f32_32x32x16_bf16 a[96:111], v[212:215], v[148:151], a[96:111]
ds_read_b64_tr_b16 v[208:209], v231 offset:33024
ds_read_b64_tr_b16 v[210:211], v231 offset:37120
v_accvgpr_read_b32 v40, a88
v_accvgpr_read_b32 v41, a89
v_accvgpr_read_b32 v42, a90
v_accvgpr_read_b32 v43, a91
v_cvt_pk_bf16_f32 v52, v40, v41
v_cvt_pk_bf16_f32 v53, v42, v43
s_waitcnt lgkmcnt(12)
v_mfma_f32_32x32x16_bf16 a[96:111], v[216:219], v[152:155], a[96:111]
ds_read_b64_tr_b16 v[212:213], v227 offset:16640
ds_read_b64_tr_b16 v[214:215], v227 offset:20736
v_accvgpr_read_b32 v44, a92
v_accvgpr_read_b32 v45, a93
v_accvgpr_read_b32 v46, a94
v_accvgpr_read_b32 v47, a95
v_cvt_pk_bf16_f32 v54, v44, v45
v_cvt_pk_bf16_f32 v55, v46, v47
s_add_u32 s63, s5, 10240
buffer_store_dwordx4 v[52:55], v238, s[24:27], s63 offen offset:1024
s_waitcnt lgkmcnt(12)
v_mfma_f32_32x32x16_bf16 a[96:111], v[220:223], v[156:159], a[96:111]
ds_read_b64_tr_b16 v[216:217], v227 offset:33024
ds_read_b64_tr_b16 v[218:219], v227 offset:37120
s_waitcnt lgkmcnt(12)
v_mfma_f32_32x32x16_bf16 a[112:127], v[192:195], v[128:131], a[112:127]
ds_read_b64_tr_b16 v[220:221], v227 offset:49408
ds_read_b64_tr_b16 v[222:223], v227 offset:53504
s_waitcnt lgkmcnt(12)
v_mfma_f32_32x32x16_bf16 a[112:127], v[196:199], v[132:135], a[112:127]
s_waitcnt lgkmcnt(10)
v_mfma_f32_32x32x16_bf16 a[112:127], v[200:203], v[136:139], a[112:127]
s_waitcnt lgkmcnt(8)
v_mfma_f32_32x32x16_bf16 a[112:127], v[204:207], v[140:143], a[112:127]
v_accvgpr_read_b32 v0, a96
v_accvgpr_read_b32 v1, a97
v_accvgpr_read_b32 v2, a98
v_accvgpr_read_b32 v3, a99
v_cvt_pk_bf16_f32 v16, v0, v1
v_cvt_pk_bf16_f32 v17, v2, v3
s_waitcnt lgkmcnt(6)
v_mfma_f32_32x32x16_bf16 a[112:127], v[208:211], v[144:147], a[112:127]
v_accvgpr_read_b32 v4, a100
v_accvgpr_read_b32 v5, a101
v_accvgpr_read_b32 v6, a102
v_accvgpr_read_b32 v7, a103
v_cvt_pk_bf16_f32 v18, v4, v5
v_cvt_pk_bf16_f32 v19, v6, v7
s_add_u32 s63, s5, 12288
buffer_store_dwordx4 v[16:19], v238, s[24:27], s63 offen offset:0
s_waitcnt lgkmcnt(4)
v_mfma_f32_32x32x16_bf16 a[112:127], v[212:215], v[148:151], a[112:127]
v_accvgpr_read_b32 v8, a104
v_accvgpr_read_b32 v9, a105
v_accvgpr_read_b32 v10, a106
v_accvgpr_read_b32 v11, a107
v_cvt_pk_bf16_f32 v20, v8, v9
v_cvt_pk_bf16_f32 v21, v10, v11
s_waitcnt lgkmcnt(2)
v_mfma_f32_32x32x16_bf16 a[112:127], v[216:219], v[152:155], a[112:127]
v_accvgpr_read_b32 v12, a108
v_accvgpr_read_b32 v13, a109
v_accvgpr_read_b32 v14, a110
v_accvgpr_read_b32 v15, a111
v_cvt_pk_bf16_f32 v22, v12, v13
v_cvt_pk_bf16_f32 v23, v14, v15
s_add_u32 s63, s5, 12288
buffer_store_dwordx4 v[20:23], v238, s[24:27], s63 offen offset:1024
s_waitcnt lgkmcnt(0)
v_mfma_f32_32x32x16_bf16 a[112:127], v[220:223], v[156:159], a[112:127]
s_nop 7
s_nop 3
v_accvgpr_read_b32 v32, a112
v_accvgpr_read_b32 v33, a113
v_accvgpr_read_b32 v34, a114
v_accvgpr_read_b32 v35, a115
v_cvt_pk_bf16_f32 v48, v32, v33
v_cvt_pk_bf16_f32 v49, v34, v35
v_accvgpr_read_b32 v36, a116
v_accvgpr_read_b32 v37, a117
v_accvgpr_read_b32 v38, a118
v_accvgpr_read_b32 v39, a119
v_cvt_pk_bf16_f32 v50, v36, v37
v_cvt_pk_bf16_f32 v51, v38, v39
s_add_u32 s63, s5, 14336
buffer_store_dwordx4 v[48:51], v238, s[24:27], s63 offen offset:0
v_accvgpr_read_b32 v40, a120
v_accvgpr_read_b32 v41, a121
v_accvgpr_read_b32 v42, a122
v_accvgpr_read_b32 v43, a123
v_cvt_pk_bf16_f32 v52, v40, v41
v_cvt_pk_bf16_f32 v53, v42, v43
v_accvgpr_read_b32 v44, a124
v_accvgpr_read_b32 v45, a125
v_accvgpr_read_b32 v46, a126
v_accvgpr_read_b32 v47, a127
v_cvt_pk_bf16_f32 v54, v44, v45
v_cvt_pk_bf16_f32 v55, v46, v47
s_add_u32 s63, s5, 14336
buffer_store_dwordx4 v[52:55], v238, s[24:27], s63 offen offset:1024
s_waitcnt vmcnt(0)
L_end:
s_endpgm
.globl mha_reduce_kernel
.p2align 8
.type mha_reduce_kernel,@function
mha_reduce_kernel:
s_cmp_ge_u32 s2, 512
s_cbranch_scc1 L_rend
s_load_dwordx2 s[4:5], s[0:1], 96
s_load_dwordx2 s[6:7], s[0:1], 80
s_lshr_b32 s16, s2, 3
s_and_b32 s17, s2, 7
s_mul_i32 s17, s17, 1
v_and_b32 v1, 63, v0
v_lshrrev_b32 v2, 6, v0
v_lshlrev_b32 v3, 4, v1
v_lshl_add_u32 v3, v2, 14, v3
s_lshl_b32 s18, s16, 18
s_lshl_b32 s19, s17, 11
s_add_u32 s18, s18, s19
s_waitcnt lgkmcnt(0)
s_mov_b32 s8, s4
s_mov_b32 s9, s5
s_mov_b32 s10, 0x2000000
s_mov_b32 s11, 0x20000
s_mov_b32 s12, s6
s_mov_b32 s13, s7
s_mov_b32 s14, 0x400000
s_mov_b32 s15, 0x20000
s_add_u32 s19, s18, 0
buffer_load_dwordx4 v[40:43], v3, s[8:11], s19 offen offset:0
buffer_load_dwordx4 v[44:47], v3, s[8:11], s19 offen offset:1024
s_add_u32 s19, s18, 65536
buffer_load_dwordx4 v[48:51], v3, s[8:11], s19 offen offset:0
buffer_load_dwordx4 v[52:55], v3, s[8:11], s19 offen offset:1024
s_add_u32 s19, s18, 131072
buffer_load_dwordx4 v[56:59], v3, s[8:11], s19 offen offset:0
buffer_load_dwordx4 v[60:63], v3, s[8:11], s19 offen offset:1024
s_add_u32 s19, s18, 196608
buffer_load_dwordx4 v[64:67], v3, s[8:11], s19 offen offset:0
buffer_load_dwordx4 v[68:71], v3, s[8:11], s19 offen offset:1024
s_and_b32 s20, s16, 31
s_lshr_b32 s21, s16, 5
s_lshl_b32 s20, s20, 17
s_lshl_b32 s21, s21, 10
s_add_u32 s20, s20, s21
s_lshl_b32 s21, s17, 6
s_add_u32 s20, s20, s21
v_and_b32 v4, 31, v1
v_and_b32 v5, 1, v2
v_lshl_add_u32 v4, v5, 5, v4
v_lshlrev_b32 v4, 11, v4
v_lshrrev_b32 v5, 1, v2
v_lshl_add_u32 v4, v5, 9, v4
v_lshrrev_b32 v5, 5, v1
v_lshl_add_u32 v4, v5, 4, v4
s_waitcnt vmcnt(6)
v_lshlrev_b32 v8, 16, v40
v_and_b32 v9, 0xffff0000, v40
v_lshlrev_b32 v10, 16, v41
v_and_b32 v11, 0xffff0000, v41
v_lshlrev_b32 v12, 16, v42
v_and_b32 v13, 0xffff0000, v42
v_lshlrev_b32 v14, 16, v43
v_and_b32 v15, 0xffff0000, v43
v_lshlrev_b32 v16, 16, v44
v_and_b32 v17, 0xffff0000, v44
v_lshlrev_b32 v18, 16, v45
v_and_b32 v19, 0xffff0000, v45
v_lshlrev_b32 v20, 16, v46
v_and_b32 v21, 0xffff0000, v46
v_lshlrev_b32 v22, 16, v47
v_and_b32 v23, 0xffff0000, v47
s_waitcnt vmcnt(4)
v_lshlrev_b32 v6, 16, v48
v_and_b32 v7, 0xffff0000, v48
v_add_f32 v8, v8, v6
v_add_f32 v9, v9, v7
v_lshlrev_b32 v6, 16, v49
v_and_b32 v7, 0xffff0000, v49
v_add_f32 v10, v10, v6
v_add_f32 v11, v11, v7
v_lshlrev_b32 v6, 16, v50
v_and_b32 v7, 0xffff0000, v50
v_add_f32 v12, v12, v6
v_add_f32 v13, v13, v7
v_lshlrev_b32 v6, 16, v51
v_and_b32 v7, 0xffff0000, v51
v_add_f32 v14, v14, v6
v_add_f32 v15, v15, v7
v_lshlrev_b32 v6, 16, v52
v_and_b32 v7, 0xffff0000, v52
v_add_f32 v16, v16, v6
v_add_f32 v17, v17, v7
v_lshlrev_b32 v6, 16, v53
v_and_b32 v7, 0xffff0000, v53
v_add_f32 v18, v18, v6
v_add_f32 v19, v19, v7
v_lshlrev_b32 v6, 16, v54
v_and_b32 v7, 0xffff0000, v54
v_add_f32 v20, v20, v6
v_add_f32 v21, v21, v7
v_lshlrev_b32 v6, 16, v55
v_and_b32 v7, 0xffff0000, v55
v_add_f32 v22, v22, v6
v_add_f32 v23, v23, v7
s_waitcnt vmcnt(2)
v_lshlrev_b32 v6, 16, v56
v_and_b32 v7, 0xffff0000, v56
v_add_f32 v8, v8, v6
v_add_f32 v9, v9, v7
v_lshlrev_b32 v6, 16, v57
v_and_b32 v7, 0xffff0000, v57
v_add_f32 v10, v10, v6
v_add_f32 v11, v11, v7
v_lshlrev_b32 v6, 16, v58
v_and_b32 v7, 0xffff0000, v58
v_add_f32 v12, v12, v6
v_add_f32 v13, v13, v7
v_lshlrev_b32 v6, 16, v59
v_and_b32 v7, 0xffff0000, v59
v_add_f32 v14, v14, v6
v_add_f32 v15, v15, v7
v_lshlrev_b32 v6, 16, v60
v_and_b32 v7, 0xffff0000, v60
v_add_f32 v16, v16, v6
v_add_f32 v17, v17, v7
v_lshlrev_b32 v6, 16, v61
v_and_b32 v7, 0xffff0000, v61
v_add_f32 v18, v18, v6
v_add_f32 v19, v19, v7
v_lshlrev_b32 v6, 16, v62
v_and_b32 v7, 0xffff0000, v62
v_add_f32 v20, v20, v6
v_add_f32 v21, v21, v7
v_lshlrev_b32 v6, 16, v63
v_and_b32 v7, 0xffff0000, v63
v_add_f32 v22, v22, v6
v_add_f32 v23, v23, v7
s_waitcnt vmcnt(0)
v_lshlrev_b32 v6, 16, v64
v_and_b32 v7, 0xffff0000, v64
v_add_f32 v8, v8, v6
v_add_f32 v9, v9, v7
v_lshlrev_b32 v6, 16, v65
v_and_b32 v7, 0xffff0000, v65
v_add_f32 v10, v10, v6
v_add_f32 v11, v11, v7
v_lshlrev_b32 v6, 16, v66
v_and_b32 v7, 0xffff0000, v66
v_add_f32 v12, v12, v6
v_add_f32 v13, v13, v7
v_lshlrev_b32 v6, 16, v67
v_and_b32 v7, 0xffff0000, v67
v_add_f32 v14, v14, v6
v_add_f32 v15, v15, v7
v_lshlrev_b32 v6, 16, v68
v_and_b32 v7, 0xffff0000, v68
v_add_f32 v16, v16, v6
v_add_f32 v17, v17, v7
v_lshlrev_b32 v6, 16, v69
v_and_b32 v7, 0xffff0000, v69
v_add_f32 v18, v18, v6
v_add_f32 v19, v19, v7
v_lshlrev_b32 v6, 16, v70
v_and_b32 v7, 0xffff0000, v70
v_add_f32 v20, v20, v6
v_add_f32 v21, v21, v7
v_lshlrev_b32 v6, 16, v71
v_and_b32 v7, 0xffff0000, v71
v_add_f32 v22, v22, v6
v_add_f32 v23, v23, v7
v_cvt_pk_bf16_f32 v24, v8, v9
v_cvt_pk_bf16_f32 v25, v10, v11
v_cvt_pk_bf16_f32 v26, v12, v13
v_cvt_pk_bf16_f32 v27, v14, v15
v_cvt_pk_bf16_f32 v28, v16, v17
v_cvt_pk_bf16_f32 v29, v18, v19
v_cvt_pk_bf16_f32 v30, v20, v21
v_cvt_pk_bf16_f32 v31, v22, v23
buffer_store_dwordx4 v[24:27], v4, s[12:15], s20 offen offset:0
buffer_store_dwordx4 v[28:31], v4, s[12:15], s20 offen offset:32
s_waitcnt vmcnt(0)
L_rend:
s_endpgm
.section .rodata,"a"
.p2align 6
.amdhsa_kernel concat_heads__mha_block_cached__mha_block_cached__near_ridge_kernel
  .amdhsa_next_free_vgpr 512
  .amdhsa_next_free_sgpr 102
  .amdhsa_accum_offset 256
  .amdhsa_group_segment_fixed_size 0
  .amdhsa_kernarg_size 104
  .amdhsa_user_sgpr_count 2
  .amdhsa_user_sgpr_kernarg_segment_ptr 1
  .amdhsa_system_sgpr_workgroup_id_x 1
.end_amdhsa_kernel
.p2align 6
.amdhsa_kernel mha_reduce_kernel
  .amdhsa_next_free_vgpr 72
  .amdhsa_next_free_sgpr 32
  .amdhsa_accum_offset 72
  .amdhsa_group_segment_fixed_size 0
  .amdhsa_kernarg_size 104
  .amdhsa_user_sgpr_count 2
  .amdhsa_user_sgpr_kernarg_segment_ptr 1
  .amdhsa_system_sgpr_workgroup_id_x 1
.end_amdhsa_kernel
```
